```python
import torch

def _softmax(x, axis=-1):
    return torch.softmax(x, dim=axis)
def _gelu(x):
    return torch.nn.functional.gelu(x, approximate="tanh")
def _silu(x):
    return torch.nn.functional.silu(x)
def _sigmoid(x):
    return torch.sigmoid(x)
def _layernorm(x, axis=-1, eps=1e-5):
    m = x.mean(dim=axis, keepdim=True)
    v = x.var(dim=axis, keepdim=True, unbiased=False)
    return (x - m) / torch.sqrt(v + eps)
def _scatter_add(tgt, idx, src, axis=0):
    return tgt.clone().index_add_(axis, idx, src)
def _segment_sum(src, seg, n):
    out = torch.zeros((n,) + src.shape[1:], dtype=src.dtype)
    return out.index_add_(0, seg, src)
def _pad(x, pw):
    flat = tuple(v for pair in reversed(pw) for v in pair)
    return torch.nn.functional.pad(x, flat)

kernel_name = 'standalone__gqa_softmax__near_ridge'

def setup_inputs():

    _w = (lambda a: (lambda t: t.to(torch.bfloat16) if t.is_floating_point() else t)(torch.as_tensor(a)))
    B, Hq, Hkv, Sq, Sk, D = 8, 32, 8, 160, 1024, 128
    return {
        "q": _w((lambda *s: torch.randn(*s, dtype=torch.bfloat16) * 0.8)(B, Hq, Sq, D)),
        "k": _w((lambda *s: torch.randn(*s, dtype=torch.bfloat16) * 0.8)(B, Hkv, Sk, D)),
        "v": _w((lambda *s: torch.randn(*s, dtype=torch.bfloat16) * 0.05)(B, Hkv, Sk, D)),
    }

def reference(q, k, v):
    B, Hq, Sq, D = q.shape
    Hkv = k.shape[1]
    rep = Hq // Hkv
    k = (lambda x, n, axis: torch.repeat_interleave(x, n, dim=axis))(k, rep, axis=1)
    v = (lambda x, n, axis: torch.repeat_interleave(x, n, dim=axis))(v, rep, axis=1)
    scale = D ** -0.5
    scores = torch.einsum("bhqd,bhkd->bhqk", q, k) * scale
    p = _softmax(scores, axis=-1)
    return torch.einsum("bhqk,bhkd->bhqd", p, v)
```

```asm
; @launch grid=(256,1,1) block=(256,1,1) lds=163840
.amdgcn_target "amdgcn-amd-amdhsa--gfx950"
.text
.globl standalone__gqa_softmax__near_ridge_kernel
.p2align 8
.type standalone__gqa_softmax__near_ridge_kernel,@function
standalone__gqa_softmax__near_ridge_kernel:
    s_cmp_ge_u32 s2, 256
    s_cbranch_scc1 L_end
    s_load_dwordx4 s[36:39], s[0:1], 0
    s_load_dwordx4 s[40:43], s[0:1], 16
    v_lshrrev_b32 v1, 6, v0
    v_and_b32 v2, 63, v0
    v_readfirstlane_b32 s3, v1
    v_lshrrev_b32 v3, 4, v2
    v_and_b32 v4, 15, v2
    v_lshlrev_b32 v19, 4, v2
    s_getpc_b64 s[56:57]
L_pc:
    s_lshr_b32 s29, s2, 3
    s_and_b32 s29, s29, 3
    s_lshl_b32 s29, s29, 2
    s_add_u32 s29, s29, s3
    s_min_u32 s29, s29, 11
    s_lshl_b32 s29, s29, 10
    s_sub_u32 s29, s29, L_pc-standalone__gqa_softmax__near_ridge_kernel
    s_ashr_i32 s30, s29, 31
    s_add_u32 s56, s56, s29
    s_addc_u32 s57, s57, s30
    v_mov_b32 v7, s57
    v_add_co_u32 v6, vcc, s56, v19
    s_nop 1
    v_addc_co_u32 v7, vcc, 0, v7, vcc
    global_load_dwordx4 a[0:3], v[6:7], off
    s_and_b32 s29, s2, 7
    s_lshr_b32 s30, s2, 3
    s_lshr_b32 s31, s2, 5
    s_lshl_b32 s24, s3, 13
    s_lshr_b32 s35, s3, 1
    s_lshl_b32 s32, s29, 5
    s_add_u32 s32, s32, s30
    s_mul_i32 s32, s32, 40960
    s_lshl_b32 s33, s29, 3
    s_add_u32 s33, s33, s31
    s_lshl_b32 s33, s33, 18
    v_xor_b32 v5, v3, v4
    v_lshlrev_b32 v5, 4, v5
    v_lshl_add_u32 v7, v3, 8, v5
    v_lshl_add_u32 v6, v4, 8, v5
    v_add_u32 v12, s24, v7
    v_xor_b32 v13, 64, v12
    v_xor_b32 v14, 128, v12
    v_xor_b32 v15, 192, v12
    s_and_b32 s90, s3, 1
    s_lshl_b32 s90, s90, 12
    s_add_u32 s90, s90, 32768
    s_add_u32 s91, s24, 4096
    s_mov_b32 s25, 0
    s_mov_b32 s26, 4096
    v_add_u32 v120, 131072, v12
    v_add_u32 v121, 131072, v13
    v_add_u32 v122, 131072, v14
    v_add_u32 v123, 131072, v15
    s_add_u32 s29, s24, 131072
    v_add_u32 v124, s29, v6
    v_xor_b32 v125, 64, v124
    v_xor_b32 v126, 128, v124
    v_xor_b32 v127, 192, v124
    s_lshl_b32 s29, s35, 14
    v_add_u32 v24, s29, v6
    v_xor_b32 v25, 64, v24
    v_xor_b32 v26, 128, v24
    v_xor_b32 v27, 192, v24
    s_mov_b32 s27, 0x3e0293ee
    s_mov_b32 s28, 0xffff0000
    s_mov_b32 s52, 0x3e0293ee
    s_mov_b32 s53, 0x3e0293ee
    s_mov_b32 s10, 40960
    s_mov_b32 s11, 0x20000
    s_mov_b32 s14, 262144
    s_mov_b32 s15, 0x20000
    s_waitcnt lgkmcnt(0)
    s_add_u32 s8, s36, s32
    s_addc_u32 s9, s37, 0
    s_and_b32 s9, s9, 0xffff
    buffer_load_dwordx4 v[96:99], v19, s[8:11], s90 offen nt
    buffer_load_dwordx4 v[100:103], v19, s[8:11], s90 offen offset:1024 nt
    buffer_load_dwordx4 v[104:107], v19, s[8:11], s90 offen offset:2048 nt
    buffer_load_dwordx4 v[108:111], v19, s[8:11], s90 offen offset:3072 nt
    s_add_u32 s12, s38, s33
    s_addc_u32 s13, s39, 0
    s_and_b32 s13, s13, 0xffff
    s_add_u32 m0, s24, 32768
    s_nop 0
    buffer_load_dwordx4 v12, s[12:15], s25 offen nt lds
    buffer_load_dwordx4 v13, s[12:15], s25 offen offset:1024 nt lds
    buffer_load_dwordx4 v14, s[12:15], s25 offen offset:2048 nt lds
    buffer_load_dwordx4 v15, s[12:15], s25 offen offset:3072 nt lds
    s_add_u32 m0, s24, 36864
    s_nop 0
    buffer_load_dwordx4 v12, s[12:15], s26 offen nt lds
    buffer_load_dwordx4 v13, s[12:15], s26 offen offset:1024 nt lds
    buffer_load_dwordx4 v14, s[12:15], s26 offen offset:2048 nt lds
    buffer_load_dwordx4 v15, s[12:15], s26 offen offset:3072 nt lds
    buffer_load_dwordx4 v[144:147], v19, s[8:11], s24 offen nt
    buffer_load_dwordx4 v[148:151], v19, s[8:11], s24 offen offset:1024 nt
    s_add_u32 s16, s40, s33
    s_addc_u32 s17, s41, 0
    s_and_b32 s17, s17, 0xffff
    s_mov_b32 s18, 262144
    s_mov_b32 s19, 0x20000
    s_add_u32 s20, s42, s32
    s_addc_u32 s21, s43, 0
    s_and_b32 s21, s21, 0xffff
    s_mov_b32 s22, 40960
    s_mov_b32 s23, 0x20000
    v_lshlrev_b32 v1, 1, v3
    v_xor_b32 v1, v1, v4
    v_lshlrev_b32 v1, 4, v1
    v_lshl_add_u32 v1, v3, 8, v1
    v_add_u32 v16, s24, v1
    v_xor_b32 v17, 128, v16
    v_xor_b32 v28, 16384, v24
    v_xor_b32 v29, 16384, v25
    v_xor_b32 v30, 16384, v26
    v_xor_b32 v31, 16384, v27
    v_add_u32 v240, 65536, v12
    v_add_u32 v241, 65536, v13
    v_add_u32 v242, 65536, v14
    v_add_u32 v243, 65536, v15
    s_add_u32 s29, s24, 65536
    v_add_u32 v244, s29, v6
    v_xor_b32 v245, 64, v244
    v_xor_b32 v246, 128, v244
    v_xor_b32 v247, 192, v244
    v_lshrrev_b32 v1, 2, v4
    v_lshl_add_u32 v1, v3, 2, v1
    v_and_b32 v5, 7, v1
    s_lshl_b32 s29, s35, 2
    v_xor_b32 v5, s29, v5
    v_lshlrev_b32 v5, 5, v5
    v_lshl_add_u32 v5, v1, 8, v5
    v_and_b32 v1, 3, v4
    v_lshl_add_u32 v5, v1, 3, v5
    s_lshl_b32 s29, s35, 14
    v_add_u32 v5, s29, v5
    v_add_u32 v32, 98304, v5
    v_xor_b32 v5, 16384, v5
    v_add_u32 v40, 98304, v5
    v_xor_b32 v33, 32, v32
    v_xor_b32 v34, 64, v32
    v_xor_b32 v35, 96, v32
    v_xor_b32 v36, 128, v32
    v_xor_b32 v37, 160, v32
    v_xor_b32 v38, 192, v32
    v_xor_b32 v39, 224, v32
    v_xor_b32 v41, 32, v40
    v_xor_b32 v42, 64, v40
    v_xor_b32 v43, 96, v40
    v_xor_b32 v44, 128, v40
    v_xor_b32 v45, 160, v40
    v_xor_b32 v46, 192, v40
    v_xor_b32 v47, 224, v40
    s_xor_b32 s29, s3, 2
    s_lshl_b32 s30, s29, 12
    s_add_u32 s30, s30, 65536
    v_add_u32 v8, s30, v19
    s_lshl_b32 s30, s3, 12
    s_add_u32 s30, s30, 65536
    v_add_u32 v9, s30, v19
    v_lshrrev_b32 v1, 1, v19
    s_lshl_b32 s30, s29, 9
    s_add_u32 s30, s30, 81920
    v_add_u32 v10, s30, v1
    s_lshl_b32 s30, s3, 9
    s_add_u32 s30, s30, 81920
    v_add_u32 v11, s30, v1
    s_mul_i32 s29, s3, 8704
    v_lshlrev_b32 v5, 3, v3
    v_mul_u32_u24 v6, 272, v4
    v_add_u32 v6, v6, v5
    v_add_u32 v18, s29, v6
    s_lshl_b32 s33, s35, 3
    v_xor_b32 v6, s33, v4
    v_lshlrev_b32 v6, 4, v6
    v_mul_u32_u24 v7, 272, v3
    v_add_u32 v6, v6, v7
    v_add_u32 v20, s29, v6
    s_add_u32 s29, s24, 98304
    v_mul_u32_u24 v6, 144, v4
    v_add_u32 v6, v6, v5
    v_add_u32 v21, s29, v6
    v_lshrrev_b32 v5, 3, v2
    v_and_b32 v6, 7, v2
    v_lshlrev_b32 v6, 4, v6
    v_mul_u32_u24 v7, 144, v5
    v_add_u32 v7, v7, v6
    v_add_u32 v22, s29, v7
    v_lshl_add_u32 v23, v5, 8, v6
    v_mov_b32 v132, 0xbe800000
    v_mov_b32 v2, 0x3f803f80
    v_mov_b32 v136, 0
    v_mov_b32 v137, 0
    v_mov_b32 v138, 0
    v_mov_b32 v139, 0
    s_add_u32 s44, s24, 32768
    s_add_u32 s45, s24, 36864
    s_add_u32 s46, s24, 0
    s_add_u32 s47, s24, 4096
    s_add_u32 s48, s24, 98304
    s_add_u32 s49, s24, 102400
    s_add_u32 s50, s24, 131072
    s_add_u32 s51, s24, 135168
    s_mov_b32 s34, 0
    v_mfma_f32_32x32x16_bf16 v[176:191], v[136:139], v[136:139], 0
    v_mfma_f32_32x32x16_bf16 v[192:207], v[136:139], v[136:139], 0
    v_mfma_f32_32x32x16_bf16 v[208:223], v[136:139], v[136:139], 0
    v_mfma_f32_32x32x16_bf16 v[224:239], v[136:139], v[136:139], 0
    v_mfma_f32_32x32x16_bf16 a[80:95], v[136:139], v[136:139], 0
    v_mfma_f32_32x32x16_bf16 a[96:111], v[136:139], v[136:139], 0
    s_nop 7
    s_nop 3
    v_accvgpr_write_b32 a108, v2
    v_accvgpr_write_b32 a109, v2
    v_accvgpr_write_b32 a110, v2
    v_accvgpr_write_b32 a111, v2
    buffer_load_dwordx4 v[152:155], v19, s[8:11], s24 offen offset:2048 nt
    buffer_load_dwordx4 v[156:159], v19, s[8:11], s24 offen offset:3072 nt
    buffer_load_dwordx4 v[160:163], v19, s[8:11], s91 offen nt
    buffer_load_dwordx4 v[164:167], v19, s[8:11], s91 offen offset:1024 nt
    buffer_load_dwordx4 v[168:171], v19, s[8:11], s91 offen offset:2048 nt
    buffer_load_dwordx4 v[172:175], v19, s[8:11], s91 offen offset:3072 nt
    s_waitcnt vmcnt(19)
    v_lshlrev_b32 v48, 16, v96
    v_lshlrev_b32 v50, 16, v97
    v_lshlrev_b32 v52, 16, v98
    v_lshlrev_b32 v54, 16, v99
    v_and_b32 v49, s28, v96
    v_and_b32 v51, s28, v97
    v_and_b32 v53, s28, v98
    v_and_b32 v55, s28, v99
    v_pk_mul_f32 v[48:49], v[48:49], s[52:53]
    v_pk_mul_f32 v[50:51], v[50:51], s[52:53]
    v_pk_mul_f32 v[52:53], v[52:53], s[52:53]
    v_pk_mul_f32 v[54:55], v[54:55], s[52:53]
    v_cvt_pk_bf16_f32 v96, v48, v49
    v_cvt_pk_bf16_f32 v97, v50, v51
    v_cvt_pk_bf16_f32 v98, v52, v53
    v_cvt_pk_bf16_f32 v99, v54, v55
    ds_write_b128 v120, v[96:99]
    s_waitcnt vmcnt(18)
    v_lshlrev_b32 v56, 16, v100
    v_lshlrev_b32 v58, 16, v101
    v_lshlrev_b32 v60, 16, v102
    v_lshlrev_b32 v62, 16, v103
    v_and_b32 v57, s28, v100
    v_and_b32 v59, s28, v101
    v_and_b32 v61, s28, v102
    v_and_b32 v63, s28, v103
    v_pk_mul_f32 v[56:57], v[56:57], s[52:53]
    v_pk_mul_f32 v[58:59], v[58:59], s[52:53]
    v_pk_mul_f32 v[60:61], v[60:61], s[52:53]
    v_pk_mul_f32 v[62:63], v[62:63], s[52:53]
    v_cvt_pk_bf16_f32 v100, v56, v57
    v_cvt_pk_bf16_f32 v101, v58, v59
    v_cvt_pk_bf16_f32 v102, v60, v61
    v_cvt_pk_bf16_f32 v103, v62, v63
    ds_write_b128 v121, v[100:103] offset:1024
    s_waitcnt vmcnt(17)
    v_lshlrev_b32 v48, 16, v104
    v_lshlrev_b32 v50, 16, v105
    v_lshlrev_b32 v52, 16, v106
    v_lshlrev_b32 v54, 16, v107
    v_and_b32 v49, s28, v104
    v_and_b32 v51, s28, v105
    v_and_b32 v53, s28, v106
    v_and_b32 v55, s28, v107
    v_pk_mul_f32 v[48:49], v[48:49], s[52:53]
    v_pk_mul_f32 v[50:51], v[50:51], s[52:53]
    v_pk_mul_f32 v[52:53], v[52:53], s[52:53]
    v_pk_mul_f32 v[54:55], v[54:55], s[52:53]
    v_cvt_pk_bf16_f32 v104, v48, v49
    v_cvt_pk_bf16_f32 v105, v50, v51
    v_cvt_pk_bf16_f32 v106, v52, v53
    v_cvt_pk_bf16_f32 v107, v54, v55
    ds_write_b128 v122, v[104:107] offset:2048
    s_waitcnt vmcnt(16)
    v_lshlrev_b32 v56, 16, v108
    v_lshlrev_b32 v58, 16, v109
    v_lshlrev_b32 v60, 16, v110
    v_lshlrev_b32 v62, 16, v111
    v_and_b32 v57, s28, v108
    v_and_b32 v59, s28, v109
    v_and_b32 v61, s28, v110
    v_and_b32 v63, s28, v111
    v_pk_mul_f32 v[56:57], v[56:57], s[52:53]
    v_pk_mul_f32 v[58:59], v[58:59], s[52:53]
    v_pk_mul_f32 v[60:61], v[60:61], s[52:53]
    v_pk_mul_f32 v[62:63], v[62:63], s[52:53]
    v_cvt_pk_bf16_f32 v108, v56, v57
    v_cvt_pk_bf16_f32 v109, v58, v59
    v_cvt_pk_bf16_f32 v110, v60, v61
    v_cvt_pk_bf16_f32 v111, v62, v63
    ds_write_b128 v123, v[108:111] offset:3072
    s_waitcnt vmcnt(8)
    s_waitcnt lgkmcnt(0)
    ds_read_b128 a[0:3], v124
    ds_read_b128 a[4:7], v125
    ds_read_b128 a[8:11], v126
    ds_read_b128 a[12:15], v127
    s_barrier
    ds_read_b128 a[16:19], v24 offset:32768
    ds_read_b128 a[20:23], v25 offset:32768
    ds_read_b128 a[24:27], v26 offset:32768
    ds_read_b128 a[28:31], v27 offset:32768
    ds_read_b128 a[32:35], v24 offset:36864
    ds_read_b128 a[36:39], v25 offset:36864
    ds_read_b128 a[40:43], v26 offset:36864
    ds_read_b128 a[44:47], v27 offset:36864
    s_waitcnt lgkmcnt(7)
    v_mfma_f32_16x16x32_bf16 v[88:91], a[16:19], a[0:3], 0
    s_waitcnt lgkmcnt(6)
    v_mfma_f32_16x16x32_bf16 v[88:91], a[20:23], a[4:7], v[88:91]
    s_waitcnt lgkmcnt(5)
    v_mfma_f32_16x16x32_bf16 v[88:91], a[24:27], a[8:11], v[88:91]
    s_waitcnt lgkmcnt(4)
    v_mfma_f32_16x16x32_bf16 v[88:91], a[28:31], a[12:15], v[88:91]
    s_waitcnt lgkmcnt(0)
    v_mfma_f32_16x16x32_bf16 v[92:95], a[32:35], a[0:3], 0
    v_mfma_f32_16x16x32_bf16 v[92:95], a[36:39], a[4:7], v[92:95]
    v_mfma_f32_16x16x32_bf16 v[92:95], a[40:43], a[8:11], v[92:95]
    v_mfma_f32_16x16x32_bf16 v[92:95], a[44:47], a[12:15], v[92:95]
    s_waitcnt vmcnt(7)
    v_lshlrev_b32 v48, 16, v144
    v_lshlrev_b32 v50, 16, v145
    v_lshlrev_b32 v52, 16, v146
    v_lshlrev_b32 v54, 16, v147
    v_and_b32 v49, s28, v144
    v_and_b32 v51, s28, v145
    v_and_b32 v53, s28, v146
    v_and_b32 v55, s28, v147
    v_mul_f32 v48, s27, v48
    v_mul_f32 v50, s27, v50
    v_mul_f32 v52, s27, v52
    v_mul_f32 v54, s27, v54
    v_mul_f32 v49, s27, v49
    v_mul_f32 v51, s27, v51
    v_mul_f32 v53, s27, v53
    v_mul_f32 v55, s27, v55
    v_cvt_pk_bf16_f32 v144, v48, v49
    v_cvt_pk_bf16_f32 v145, v50, v51
    v_cvt_pk_bf16_f32 v146, v52, v53
    v_cvt_pk_bf16_f32 v147, v54, v55
    ds_write_b128 v240, v[144:147]
    v_max3_f32 v48, v88, v89, v90
    v_max3_f32 v49, v91, v92, v93
    v_max3_f32 v48, v48, v94, v95
    s_nop 0
    v_max_f32 v48, v48, v49
    v_mov_b32 v49, v48
    s_nop 1
    v_permlane16_swap_b32 v48, v49
    v_max_f32 v48, v48, v49
    v_mov_b32 v49, v48
    s_nop 1
    v_permlane32_swap_b32 v48, v49
    v_max_f32 v135, v48, v49
    s_nop 1
    v_mfma_f32_16x16x4_f32 v[88:91], v132, v135, v[88:91]
    v_mfma_f32_16x16x4_f32 v[92:95], v132, v135, v[92:95]
    v_mfma_f32_16x16x4_f32 v[128:131], v132, v135, 0
    s_waitcnt vmcnt(6)
    v_lshlrev_b32 v56, 16, v148
    v_lshlrev_b32 v58, 16, v149
    v_lshlrev_b32 v60, 16, v150
    v_lshlrev_b32 v62, 16, v151
    v_and_b32 v57, s28, v148
    v_and_b32 v59, s28, v149
    v_and_b32 v61, s28, v150
    v_and_b32 v63, s28, v151
    v_mul_f32 v56, s27, v56
    v_mul_f32 v58, s27, v58
    v_mul_f32 v60, s27, v60
    v_mul_f32 v62, s27, v62
    v_mul_f32 v57, s27, v57
    v_mul_f32 v59, s27, v59
    v_mul_f32 v61, s27, v61
    v_mul_f32 v63, s27, v63
    v_cvt_pk_bf16_f32 v148, v56, v57
    v_cvt_pk_bf16_f32 v149, v58, v59
    v_cvt_pk_bf16_f32 v150, v60, v61
    v_cvt_pk_bf16_f32 v151, v62, v63
    ds_write_b128 v241, v[148:151] offset:1024
    s_mov_b32 m0, s48
    s_nop 0
    buffer_load_dwordx4 v16, s[16:19], s25 offen nt lds
    buffer_load_dwordx4 v17, s[16:19], s25 offen offset:1024 nt lds
    buffer_load_dwordx4 v16, s[16:19], s25 offen offset:2048 nt lds
    buffer_load_dwordx4 v17, s[16:19], s25 offen offset:3072 nt lds
    s_mov_b32 m0, s49
    s_nop 0
    buffer_load_dwordx4 v16, s[16:19], s26 offen nt lds
    buffer_load_dwordx4 v17, s[16:19], s26 offen offset:1024 nt lds
    buffer_load_dwordx4 v16, s[16:19], s26 offen offset:2048 nt lds
    buffer_load_dwordx4 v17, s[16:19], s26 offen offset:3072 nt lds
    s_waitcnt vmcnt(13)
    v_lshlrev_b32 v48, 16, v152
    v_lshlrev_b32 v50, 16, v153
    v_lshlrev_b32 v52, 16, v154
    v_lshlrev_b32 v54, 16, v155
    v_and_b32 v49, s28, v152
    v_and_b32 v51, s28, v153
    v_and_b32 v53, s28, v154
    v_and_b32 v55, s28, v155
    v_pk_mul_f32 v[48:49], v[48:49], s[52:53]
    v_pk_mul_f32 v[50:51], v[50:51], s[52:53]
    v_pk_mul_f32 v[52:53], v[52:53], s[52:53]
    v_pk_mul_f32 v[54:55], v[54:55], s[52:53]
    v_cvt_pk_bf16_f32 v152, v48, v49
    v_cvt_pk_bf16_f32 v153, v50, v51
    v_cvt_pk_bf16_f32 v154, v52, v53
    v_cvt_pk_bf16_f32 v155, v54, v55
    ds_write_b128 v242, v[152:155] offset:2048
    s_waitcnt vmcnt(12)
    v_lshlrev_b32 v56, 16, v156
    v_lshlrev_b32 v58, 16, v157
    v_lshlrev_b32 v60, 16, v158
    v_lshlrev_b32 v62, 16, v159
    v_and_b32 v57, s28, v156
    v_and_b32 v59, s28, v157
    v_and_b32 v61, s28, v158
    v_and_b32 v63, s28, v159
    v_pk_mul_f32 v[56:57], v[56:57], s[52:53]
    v_pk_mul_f32 v[58:59], v[58:59], s[52:53]
    v_pk_mul_f32 v[60:61], v[60:61], s[52:53]
    v_pk_mul_f32 v[62:63], v[62:63], s[52:53]
    v_cvt_pk_bf16_f32 v156, v56, v57
    v_cvt_pk_bf16_f32 v157, v58, v59
    v_cvt_pk_bf16_f32 v158, v60, v61
    v_cvt_pk_bf16_f32 v159, v62, v63
    ds_write_b128 v243, v[156:159] offset:3072
    s_waitcnt vmcnt(11)
    v_lshlrev_b32 v48, 16, v160
    v_lshlrev_b32 v50, 16, v161
    v_lshlrev_b32 v52, 16, v162
    v_lshlrev_b32 v54, 16, v163
    v_and_b32 v49, s28, v160
    v_and_b32 v51, s28, v161
    v_and_b32 v53, s28, v162
    v_and_b32 v55, s28, v163
    v_pk_mul_f32 v[48:49], v[48:49], s[52:53]
    v_pk_mul_f32 v[50:51], v[50:51], s[52:53]
    v_pk_mul_f32 v[52:53], v[52:53], s[52:53]
    v_pk_mul_f32 v[54:55], v[54:55], s[52:53]
    v_cvt_pk_bf16_f32 v160, v48, v49
    v_cvt_pk_bf16_f32 v161, v50, v51
    v_cvt_pk_bf16_f32 v162, v52, v53
    v_cvt_pk_bf16_f32 v163, v54, v55
    ds_write_b128 v240, v[160:163] offset:4096
    s_waitcnt vmcnt(10)
    v_lshlrev_b32 v56, 16, v164
    v_lshlrev_b32 v58, 16, v165
    v_lshlrev_b32 v60, 16, v166
    v_lshlrev_b32 v62, 16, v167
    v_and_b32 v57, s28, v164
    v_and_b32 v59, s28, v165
    v_and_b32 v61, s28, v166
    v_and_b32 v63, s28, v167
    v_pk_mul_f32 v[56:57], v[56:57], s[52:53]
    v_pk_mul_f32 v[58:59], v[58:59], s[52:53]
    v_pk_mul_f32 v[60:61], v[60:61], s[52:53]
    v_pk_mul_f32 v[62:63], v[62:63], s[52:53]
    v_cvt_pk_bf16_f32 v164, v56, v57
    v_cvt_pk_bf16_f32 v165, v58, v59
    v_cvt_pk_bf16_f32 v166, v60, v61
    v_cvt_pk_bf16_f32 v167, v62, v63
    ds_write_b128 v241, v[164:167] offset:5120
    s_waitcnt vmcnt(9)
    v_lshlrev_b32 v48, 16, v168
    v_lshlrev_b32 v50, 16, v169
    v_lshlrev_b32 v52, 16, v170
    v_lshlrev_b32 v54, 16, v171
    v_and_b32 v49, s28, v168
    v_and_b32 v51, s28, v169
    v_and_b32 v53, s28, v170
    v_and_b32 v55, s28, v171
    v_pk_mul_f32 v[48:49], v[48:49], s[52:53]
    v_pk_mul_f32 v[50:51], v[50:51], s[52:53]
    v_pk_mul_f32 v[52:53], v[52:53], s[52:53]
    v_pk_mul_f32 v[54:55], v[54:55], s[52:53]
    v_cvt_pk_bf16_f32 v168, v48, v49
    v_cvt_pk_bf16_f32 v169, v50, v51
    v_cvt_pk_bf16_f32 v170, v52, v53
    v_cvt_pk_bf16_f32 v171, v54, v55
    ds_write_b128 v242, v[168:171] offset:6144
    s_waitcnt vmcnt(8)
    v_lshlrev_b32 v56, 16, v172
    v_lshlrev_b32 v58, 16, v173
    v_lshlrev_b32 v60, 16, v174
    v_lshlrev_b32 v62, 16, v175
    v_and_b32 v57, s28, v172
    v_and_b32 v59, s28, v173
    v_and_b32 v61, s28, v174
    v_and_b32 v63, s28, v175
    v_pk_mul_f32 v[56:57], v[56:57], s[52:53]
    v_pk_mul_f32 v[58:59], v[58:59], s[52:53]
    v_pk_mul_f32 v[60:61], v[60:61], s[52:53]
    v_pk_mul_f32 v[62:63], v[62:63], s[52:53]
    v_cvt_pk_bf16_f32 v172, v56, v57
    v_cvt_pk_bf16_f32 v173, v58, v59
    v_cvt_pk_bf16_f32 v174, v60, v61
    v_cvt_pk_bf16_f32 v175, v62, v63
    ds_write_b128 v243, v[172:175] offset:7168
    s_mov_b32 s25, 32768
    s_mov_b32 s26, 36864
    s_waitcnt lgkmcnt(0)
    ds_read_b128 v[144:147], v244
    ds_read_b128 v[148:151], v245
    ds_read_b128 v[152:155], v246
    ds_read_b128 v[156:159], v247
    ds_read_b128 v[160:163], v244 offset:4096
    ds_read_b128 v[164:167], v245 offset:4096
    ds_read_b128 v[168:171], v246 offset:4096
    ds_read_b128 v[172:175], v247 offset:4096
    s_waitcnt lgkmcnt(7)
    v_mfma_f32_16x16x32_bf16 v[72:75], a[16:19], v[144:147], 0
    s_waitcnt lgkmcnt(6)
    v_mfma_f32_16x16x32_bf16 v[72:75], a[20:23], v[148:151], v[72:75]
    s_waitcnt lgkmcnt(5)
    v_mfma_f32_16x16x32_bf16 v[72:75], a[24:27], v[152:155], v[72:75]
    s_waitcnt lgkmcnt(4)
    v_mfma_f32_16x16x32_bf16 v[72:75], a[28:31], v[156:159], v[72:75]
    v_mfma_f32_16x16x32_bf16 v[76:79], a[32:35], v[144:147], 0
    v_mfma_f32_16x16x32_bf16 v[76:79], a[36:39], v[148:151], v[76:79]
    v_mfma_f32_16x16x32_bf16 v[76:79], a[40:43], v[152:155], v[76:79]
    v_mfma_f32_16x16x32_bf16 v[76:79], a[44:47], v[156:159], v[76:79]
    s_waitcnt lgkmcnt(0)
    v_mfma_f32_16x16x32_bf16 v[80:83], a[16:19], v[160:163], 0
    v_mfma_f32_16x16x32_bf16 v[80:83], a[20:23], v[164:167], v[80:83]
    v_mfma_f32_16x16x32_bf16 v[80:83], a[24:27], v[168:171], v[80:83]
    v_mfma_f32_16x16x32_bf16 v[80:83], a[28:31], v[172:175], v[80:83]
    v_mfma_f32_16x16x32_bf16 v[84:87], a[32:35], v[160:163], 0
    v_mfma_f32_16x16x32_bf16 v[84:87], a[36:39], v[164:167], v[84:87]
    v_mfma_f32_16x16x32_bf16 v[84:87], a[40:43], v[168:171], v[84:87]
    v_mfma_f32_16x16x32_bf16 v[84:87], a[44:47], v[172:175], v[84:87]
    v_mfma_f32_32x32x16_bf16 v[240:255], v[136:139], v[136:139], 0
    s_mov_b32 m0, s46
    s_nop 0
    buffer_load_dwordx4 v12, s[12:15], s25 offen nt lds
    buffer_load_dwordx4 v13, s[12:15], s25 offen offset:1024 nt lds
    buffer_load_dwordx4 v14, s[12:15], s25 offen offset:2048 nt lds
    buffer_load_dwordx4 v15, s[12:15], s25 offen offset:3072 nt lds
    s_mov_b32 m0, s47
    s_nop 0
    buffer_load_dwordx4 v12, s[12:15], s26 offen nt lds
    buffer_load_dwordx4 v13, s[12:15], s26 offen offset:1024 nt lds
    buffer_load_dwordx4 v14, s[12:15], s26 offen offset:2048 nt lds
    buffer_load_dwordx4 v15, s[12:15], s26 offen offset:3072 nt lds
    ds_read_b128 a[16:19], v24 offset:40960
    ds_read_b128 a[20:23], v25 offset:40960
    ds_read_b128 a[24:27], v26 offset:40960
    ds_read_b128 a[28:31], v27 offset:40960
    ds_read_b128 a[32:35], v24 offset:45056
    ds_read_b128 a[36:39], v25 offset:45056
    ds_read_b128 a[40:43], v26 offset:45056
    ds_read_b128 a[44:47], v27 offset:45056
    v_max3_f32 v140, v72, v73, v74
    v_max3_f32 v141, v75, v76, v77
    v_max3_f32 v142, v80, v81, v82
    v_max3_f32 v143, v83, v84, v85
    v_max3_f32 v140, v140, v78, v79
    v_max3_f32 v142, v142, v86, v87
    v_max_f32 v140, v140, v141
    v_max_f32 v142, v142, v143
    v_mov_b32 v141, v140
    v_mov_b32 v143, v142
    s_nop 0
    v_permlane16_swap_b32 v140, v141
    v_permlane16_swap_b32 v142, v143
    v_max_f32 v140, v140, v141
    v_max_f32 v142, v142, v143
    v_mov_b32 v141, v140
    v_mov_b32 v143, v142
    s_nop 0
    v_permlane32_swap_b32 v140, v141
    v_permlane32_swap_b32 v142, v143
    v_max_f32 v133, v140, v141
    v_max_f32 v134, v142, v143
    s_nop 1
    v_mfma_f32_16x16x4_f32 v[72:75], v132, v133, v[72:75]
    v_mfma_f32_16x16x4_f32 v[76:79], v132, v133, v[76:79]
    v_mfma_f32_16x16x4_f32 v[80:83], v132, v134, v[80:83]
    v_mfma_f32_16x16x4_f32 v[84:87], v132, v134, v[84:87]
    v_mfma_f32_16x16x4_f32 v[120:123], v132, v133, 0
    v_mfma_f32_16x16x4_f32 v[124:127], v132, v134, 0
    s_nop 5
    v_exp_f32 v72, v72
    v_exp_f32 v73, v73
    v_exp_f32 v74, v74
    v_cvt_pk_bf16_f32 v48, v72, v73
    v_exp_f32 v75, v75
    v_exp_f32 v76, v76
    v_cvt_pk_bf16_f32 v49, v74, v75
    v_exp_f32 v77, v77
    v_exp_f32 v78, v78
    v_cvt_pk_bf16_f32 v50, v76, v77
    v_exp_f32 v79, v79
    v_exp_f32 v80, v80
    v_cvt_pk_bf16_f32 v51, v78, v79
    v_exp_f32 v81, v81
    v_exp_f32 v82, v82
    v_cvt_pk_bf16_f32 v52, v80, v81
    v_exp_f32 v83, v83
    v_exp_f32 v84, v84
    v_cvt_pk_bf16_f32 v53, v82, v83
    v_exp_f32 v85, v85
    v_exp_f32 v86, v86
    v_cvt_pk_bf16_f32 v54, v84, v85
    v_exp_f32 v87, v87
    v_exp_f32 v88, v88
    v_cvt_pk_bf16_f32 v55, v86, v87
    s_waitcnt vmcnt(8)
    s_barrier
    ds_read_b64_tr_b16 a[62:63], v35 offset:4096
    ds_read_b64_tr_b16 a[60:61], v35
    s_mov_b32 m0, s50
    s_nop 0
    buffer_load_dwordx4 v16, s[16:19], s25 offen nt lds
    buffer_load_dwordx4 v17, s[16:19], s25 offen offset:1024 nt lds
    s_mov_b32 m0, s51
    s_nop 0
    s_mov_b32 m0, s50
    s_waitcnt lgkmcnt(0)
.p2align 6
L_loop:
    v_exp_f32 v89, v89
    v_mfma_f32_16x16x32_bf16 v[96:99], a[16:19], v[144:147], v[120:123]
    ds_read_b64_tr_b16 a[58:59], v34 offset:4096
    v_cvt_pk_bf16_f32 v56, v88, v89
    v_mfma_f32_16x16x32_bf16 v[96:99], a[20:23], v[148:151], v[96:99]
    v_exp_f32 v90, v90
    v_mfma_f32_16x16x32_bf16 v[96:99], a[24:27], v[152:155], v[96:99]
    buffer_load_dwordx4 v16, s[16:19], s25 offen offset:2048 nt lds
    v_mfma_f32_16x16x32_bf16 v[96:99], a[28:31], v[156:159], v[96:99]
    v_exp_f32 v91, v91
    v_mfma_f32_16x16x32_bf16 v[100:103], a[32:35], v[144:147], v[120:123]
    s_waitcnt lgkmcnt(1)
    ds_read_b64_tr_b16 a[48:49], v32
    v_cvt_pk_bf16_f32 v57, v90, v91
    v_mfma_f32_16x16x32_bf16 v[100:103], a[36:39], v[148:151], v[100:103]
    v_exp_f32 v92, v92
    v_mfma_f32_16x16x32_bf16 v[100:103], a[40:43], v[152:155], v[100:103]
    buffer_load_dwordx4 v17, s[16:19], s25 offen offset:3072 nt lds
    v_mfma_f32_16x16x32_bf16 v[100:103], a[44:47], v[156:159], v[100:103]
    v_exp_f32 v93, v93
    v_mfma_f32_16x16x32_bf16 v[104:107], a[16:19], v[160:163], v[124:127]
    ds_read_b64_tr_b16 a[50:51], v32 offset:4096
    v_cvt_pk_bf16_f32 v58, v92, v93
    v_mfma_f32_16x16x32_bf16 v[104:107], a[20:23], v[164:167], v[104:107]
    s_max_u32 m0, s51, s34
    v_exp_f32 v94, v94
    v_mfma_f32_16x16x32_bf16 v[104:107], a[24:27], v[168:171], v[104:107]
    buffer_load_dwordx4 v16, s[16:19], s26 offen nt lds
    v_mfma_f32_16x16x32_bf16 v[104:107], a[28:31], v[172:175], v[104:107]
    v_exp_f32 v95, v95
    v_mfma_f32_16x16x32_bf16 v[108:111], a[32:35], v[160:163], v[124:127]
    ds_read_b64_tr_b16 a[52:53], v33
    v_cvt_pk_bf16_f32 v59, v94, v95
    v_mfma_f32_16x16x32_bf16 v[108:111], a[36:39], v[164:167], v[108:111]
    v_exp_f32 v96, v96
    v_mfma_f32_16x16x32_bf16 v[108:111], a[40:43], v[168:171], v[108:111]
    buffer_load_dwordx4 v17, s[16:19], s26 offen offset:1024 nt lds
    v_mfma_f32_16x16x32_bf16 v[108:111], a[44:47], v[172:175], v[108:111]
    v_exp_f32 v97, v97
    v_mfma_f32_16x16x32_bf16 v[112:115], a[16:19], a[0:3], v[128:131]
    ds_read_b64_tr_b16 a[54:55], v33 offset:4096
    v_cvt_pk_bf16_f32 v60, v96, v97
    v_mfma_f32_16x16x32_bf16 v[112:115], a[20:23], a[4:7], v[112:115]
    v_exp_f32 v98, v98
    v_mfma_f32_16x16x32_bf16 v[112:115], a[24:27], a[8:11], v[112:115]
    buffer_load_dwordx4 v16, s[16:19], s26 offen offset:2048 nt lds
    v_mfma_f32_16x16x32_bf16 v[112:115], a[28:31], a[12:15], v[112:115]
    v_exp_f32 v99, v99
    v_mfma_f32_16x16x32_bf16 v[116:119], a[32:35], a[0:3], v[128:131]
    ds_read_b64_tr_b16 a[56:57], v34
    v_cvt_pk_bf16_f32 v61, v98, v99
    v_mfma_f32_16x16x32_bf16 v[116:119], a[36:39], a[4:7], v[116:119]
    v_exp_f32 v100, v100
    v_mfma_f32_16x16x32_bf16 v[116:119], a[40:43], a[8:11], v[116:119]
    buffer_load_dwordx4 v17, s[16:19], s26 offen offset:3072 nt lds
    v_mfma_f32_16x16x32_bf16 v[116:119], a[44:47], a[12:15], v[116:119]
    s_waitcnt lgkmcnt(1)
    v_exp_f32 v101, v101
    v_mfma_f32_16x16x32_bf16 v[176:179], a[48:51], v[48:51], v[176:179]
    ds_read_b64_tr_b16 a[70:71], v37 offset:4096
    v_cvt_pk_bf16_f32 v62, v100, v101
    v_mfma_f32_16x16x32_bf16 v[180:183], a[52:55], v[48:51], v[180:183]
    v_exp_f32 v102, v102
    v_mfma_f32_16x16x32_bf16 v[208:211], a[48:51], v[52:55], v[208:211]
    ds_read_b64_tr_b16 a[64:65], v36
    ds_read_b64_tr_b16 a[68:69], v37
    v_mfma_f32_16x16x32_bf16 v[212:215], a[52:55], v[52:55], v[212:215]
    v_exp_f32 v103, v103
    v_mfma_f32_16x16x32_bf16 v[240:243], a[48:51], v[56:59], v[240:243]
    ds_read_b64_tr_b16 a[66:67], v36 offset:4096
    v_cvt_pk_bf16_f32 v63, v102, v103
    v_mfma_f32_16x16x32_bf16 v[244:247], a[52:55], v[56:59], v[244:247]
    s_waitcnt lgkmcnt(4)
    v_exp_f32 v104, v104
    v_mfma_f32_16x16x32_bf16 v[184:187], a[56:59], v[48:51], v[184:187]
    ds_read_b64_tr_b16 a[72:73], v38
    ds_read_b64_tr_b16 a[78:79], v39 offset:4096
    v_mfma_f32_16x16x32_bf16 v[188:191], a[60:63], v[48:51], v[188:191]
    v_exp_f32 v105, v105
    v_mfma_f32_16x16x32_bf16 v[216:219], a[56:59], v[52:55], v[216:219]
    ds_read_b64_tr_b16 a[76:77], v39
    v_cvt_pk_bf16_f32 v64, v104, v105
    v_mfma_f32_16x16x32_bf16 v[220:223], a[60:63], v[52:55], v[220:223]
    v_exp_f32 v106, v106
    v_mfma_f32_16x16x32_bf16 v[248:251], a[56:59], v[56:59], v[248:251]
    ds_read_b64_tr_b16 a[74:75], v38 offset:4096
    ds_read_b128 a[16:19], v28 offset:32768
    v_mfma_f32_16x16x32_bf16 v[252:255], a[60:63], v[56:59], v[252:255]
    s_waitcnt lgkmcnt(5)
    v_exp_f32 v107, v107
    v_mfma_f32_16x16x32_bf16 v[192:195], a[64:67], v[48:51], v[192:195]
    ds_read_b128 a[24:27], v30 offset:32768
    v_cvt_pk_bf16_f32 v65, v106, v107
    v_mfma_f32_16x16x32_bf16 v[196:199], a[68:71], v[48:51], v[196:199]
    v_exp_f32 v108, v108
    v_mfma_f32_16x16x32_bf16 v[224:227], a[64:67], v[52:55], v[224:227]
    ds_read_b128 a[20:23], v29 offset:32768
    ds_read_b128 a[36:39], v29 offset:36864
    v_mfma_f32_16x16x32_bf16 v[228:231], a[68:71], v[52:55], v[228:231]
    s_add_u32 s25, s25, 0x8000
    v_exp_f32 v109, v109
    v_mfma_f32_16x16x32_bf16 a[80:83], a[64:67], v[56:59], a[80:83]
    ds_read_b128 a[40:43], v30 offset:36864
    v_cvt_pk_bf16_f32 v66, v108, v109
    v_mfma_f32_16x16x32_bf16 a[84:87], a[68:71], v[56:59], a[84:87]
    s_waitcnt lgkmcnt(4)
    s_add_u32 s26, s26, 0x8000
    v_exp_f32 v110, v110
    v_mfma_f32_16x16x32_bf16 v[200:203], a[72:75], v[48:51], v[200:203]
    ds_read_b128 a[44:47], v31 offset:36864
    ds_read_b64_tr_b16 a[70:71], v37 offset:12288
    v_mfma_f32_16x16x32_bf16 v[204:207], a[76:79], v[48:51], v[204:207]
    s_cmp_ge_u32 s25, 0x40000
    v_exp_f32 v111, v111
    v_mfma_f32_16x16x32_bf16 v[232:235], a[72:75], v[52:55], v[232:235]
    ds_read_b128 a[28:31], v31 offset:32768
    v_cvt_pk_bf16_f32 v67, v110, v111
    v_mfma_f32_16x16x32_bf16 v[236:239], a[76:79], v[52:55], v[236:239]
    s_cselect_b32 s34, 0x30000, 0
    v_exp_f32 v112, v112
    v_mfma_f32_16x16x32_bf16 a[88:91], a[72:75], v[56:59], a[88:91]
    ds_read_b128 a[32:35], v28 offset:36864
    ds_read_b64_tr_b16 a[72:73], v38 offset:8192
    v_mfma_f32_16x16x32_bf16 a[92:95], a[76:79], v[56:59], a[92:95]
    v_exp_f32 v113, v113
    v_mfma_f32_16x16x32_bf16 a[96:99], a[108:111], v[48:51], a[96:99]
    ds_read_b64_tr_b16 a[48:49], v32 offset:8192
    v_cvt_pk_bf16_f32 v68, v112, v113
    v_mfma_f32_16x16x32_bf16 a[100:103], a[108:111], v[52:55], a[100:103]
    v_exp_f32 v114, v114
    v_mfma_f32_16x16x32_bf16 a[104:107], a[108:111], v[56:59], a[104:107]
    ds_read_b64_tr_b16 a[50:51], v32 offset:12288
    ds_read_b64_tr_b16 a[68:69], v37 offset:8192
    v_mfma_f32_16x16x32_bf16 v[72:75], a[16:19], v[144:147], v[120:123]
    s_waitcnt lgkmcnt(5)
    v_exp_f32 v115, v115
    v_mfma_f32_16x16x32_bf16 v[72:75], a[20:23], v[148:151], v[72:75]
    ds_read_b64_tr_b16 a[52:53], v33 offset:8192
    v_cvt_pk_bf16_f32 v69, v114, v115
    v_mfma_f32_16x16x32_bf16 v[72:75], a[24:27], v[152:155], v[72:75]
    v_exp_f32 v116, v116
    v_mfma_f32_16x16x32_bf16 v[72:75], a[28:31], v[156:159], v[72:75]
    s_waitcnt lgkmcnt(3)
    ds_read_b64_tr_b16 a[54:55], v33 offset:12288
    ds_read_b64_tr_b16 a[74:75], v38 offset:12288
    v_mfma_f32_16x16x32_bf16 v[76:79], a[32:35], v[144:147], v[120:123]
    v_exp_f32 v117, v117
    v_mfma_f32_16x16x32_bf16 v[76:79], a[36:39], v[148:151], v[76:79]
    ds_read_b64_tr_b16 a[58:59], v34 offset:12288
    v_cvt_pk_bf16_f32 v70, v116, v117
    v_mfma_f32_16x16x32_bf16 v[76:79], a[40:43], v[152:155], v[76:79]
    v_exp_f32 v118, v118
    v_mfma_f32_16x16x32_bf16 v[76:79], a[44:47], v[156:159], v[76:79]
    ds_read_b64_tr_b16 a[62:63], v35 offset:12288
    ds_read_b64_tr_b16 a[78:79], v39 offset:12288
    v_mfma_f32_16x16x32_bf16 v[80:83], a[16:19], v[160:163], v[124:127]
    v_exp_f32 v119, v119
    v_mfma_f32_16x16x32_bf16 v[80:83], a[20:23], v[164:167], v[80:83]
    ds_read_b64_tr_b16 a[66:67], v36 offset:12288
    v_cvt_pk_bf16_f32 v71, v118, v119
    v_mfma_f32_16x16x32_bf16 v[80:83], a[24:27], v[168:171], v[80:83]
    v_exp_f32 v72, v72
    v_mfma_f32_16x16x32_bf16 v[80:83], a[28:31], v[172:175], v[80:83]
    ds_read_b64_tr_b16 a[56:57], v34 offset:8192
    ds_read_b128 a[20:23], v29 offset:40960
    v_mfma_f32_16x16x32_bf16 v[84:87], a[32:35], v[160:163], v[124:127]
    v_exp_f32 v73, v73
    v_mfma_f32_16x16x32_bf16 v[84:87], a[36:39], v[164:167], v[84:87]
    ds_read_b128 a[28:31], v31 offset:40960
    v_cvt_pk_bf16_f32 v48, v72, v73
    v_mfma_f32_16x16x32_bf16 v[84:87], a[40:43], v[168:171], v[84:87]
    v_exp_f32 v74, v74
    v_mfma_f32_16x16x32_bf16 v[84:87], a[44:47], v[172:175], v[84:87]
    s_waitcnt lgkmcnt(3)
    ds_read_b64_tr_b16 a[60:61], v35 offset:8192
    ds_read_b128 a[36:39], v29 offset:45056
    v_mfma_f32_16x16x32_bf16 v[176:179], a[48:51], v[60:63], v[176:179]
    v_exp_f32 v75, v75
    v_mfma_f32_16x16x32_bf16 v[180:183], a[52:55], v[60:63], v[180:183]
    ds_read_b128 a[44:47], v31 offset:45056
    v_cvt_pk_bf16_f32 v49, v74, v75
    v_mfma_f32_16x16x32_bf16 v[208:211], a[48:51], v[64:67], v[208:211]
    v_exp_f32 v76, v76
    v_mfma_f32_16x16x32_bf16 v[212:215], a[52:55], v[64:67], v[212:215]
    ds_read_b64_tr_b16 a[64:65], v36 offset:8192
    ds_read_b128 a[40:43], v30 offset:45056
    v_mfma_f32_16x16x32_bf16 v[240:243], a[48:51], v[68:71], v[240:243]
    v_exp_f32 v77, v77
    v_mfma_f32_16x16x32_bf16 v[244:247], a[52:55], v[68:71], v[244:247]
    s_waitcnt lgkmcnt(3)
    ds_read_b128 a[32:35], v28 offset:45056
    v_cvt_pk_bf16_f32 v50, v76, v77
    v_mfma_f32_16x16x32_bf16 v[184:187], a[56:59], v[60:63], v[184:187]
    v_exp_f32 v78, v78
    v_mfma_f32_16x16x32_bf16 v[188:191], a[60:63], v[60:63], v[188:191]
    ds_read_b128 a[24:27], v30 offset:40960
    ds_read_b64_tr_b16 a[50:51], v40 offset:4096
    v_mfma_f32_16x16x32_bf16 v[216:219], a[56:59], v[64:67], v[216:219]
    v_exp_f32 v79, v79
    v_mfma_f32_16x16x32_bf16 v[220:223], a[60:63], v[64:67], v[220:223]
    ds_read_b128 a[16:19], v28 offset:40960
    v_cvt_pk_bf16_f32 v51, v78, v79
    v_mfma_f32_16x16x32_bf16 v[248:251], a[56:59], v[68:71], v[248:251]
    v_exp_f32 v80, v80
    v_mfma_f32_16x16x32_bf16 v[252:255], a[60:63], v[68:71], v[252:255]
    s_waitcnt lgkmcnt(3)
    ds_read_b64_tr_b16 a[76:77], v39 offset:8192
    ds_read_b64_tr_b16 a[52:53], v41
    v_mfma_f32_16x16x32_bf16 v[192:195], a[64:67], v[60:63], v[192:195]
    v_exp_f32 v81, v81
    v_mfma_f32_16x16x32_bf16 v[196:199], a[68:71], v[60:63], v[196:199]
    ds_read_b64_tr_b16 a[58:59], v42 offset:4096
    v_cvt_pk_bf16_f32 v52, v80, v81
    v_mfma_f32_16x16x32_bf16 v[224:227], a[64:67], v[64:67], v[224:227]
    v_exp_f32 v82, v82
    v_mfma_f32_16x16x32_bf16 v[228:231], a[68:71], v[64:67], v[228:231]
    ds_read_b64_tr_b16 a[54:55], v41 offset:4096
    ds_read_b64_tr_b16 a[60:61], v43
    v_mfma_f32_16x16x32_bf16 a[80:83], a[64:67], v[68:71], a[80:83]
    v_exp_f32 v83, v83
    v_mfma_f32_16x16x32_bf16 a[84:87], a[68:71], v[68:71], a[84:87]
    ds_read_b64_tr_b16 a[64:65], v44
    v_cvt_pk_bf16_f32 v53, v82, v83
    v_mfma_f32_16x16x32_bf16 v[200:203], a[72:75], v[60:63], v[200:203]
    s_waitcnt lgkmcnt(4)
    v_exp_f32 v84, v84
    v_mfma_f32_16x16x32_bf16 v[204:207], a[76:79], v[60:63], v[204:207]
    ds_read_b64_tr_b16 a[56:57], v42
    ds_read_b64_tr_b16 a[66:67], v44 offset:4096
    v_mfma_f32_16x16x32_bf16 v[232:235], a[72:75], v[64:67], v[232:235]
    v_exp_f32 v85, v85
    v_mfma_f32_16x16x32_bf16 v[236:239], a[76:79], v[64:67], v[236:239]
    ds_read_b64_tr_b16 a[68:69], v45
    v_cvt_pk_bf16_f32 v54, v84, v85
    v_mfma_f32_16x16x32_bf16 a[88:91], a[72:75], v[68:71], a[88:91]
    v_exp_f32 v86, v86
    v_mfma_f32_16x16x32_bf16 a[92:95], a[76:79], v[68:71], a[92:95]
    s_waitcnt vmcnt(8)
    s_barrier
    v_mfma_f32_16x16x32_bf16 a[96:99], a[108:111], v[60:63], a[96:99]
    v_exp_f32 v87, v87
    v_mfma_f32_16x16x32_bf16 a[100:103], a[108:111], v[64:67], a[100:103]
    ds_read_b64_tr_b16 a[72:73], v46
    v_cvt_pk_bf16_f32 v55, v86, v87
    v_mfma_f32_16x16x32_bf16 a[104:107], a[108:111], v[68:71], a[104:107]
    s_max_u32 m0, s44, s34
    ds_read_b64_tr_b16 a[74:75], v46 offset:4096
    v_mfma_f32_16x16x32_bf16 v[96:99], a[16:19], v[144:147], v[120:123]
    buffer_load_dwordx4 v12, s[12:15], s25 offen nt lds
    v_mfma_f32_16x16x32_bf16 v[96:99], a[20:23], v[148:151], v[96:99]
    ds_read_b64_tr_b16 a[76:77], v47
    v_mfma_f32_16x16x32_bf16 v[96:99], a[24:27], v[152:155], v[96:99]
    ds_read_b64_tr_b16 a[78:79], v47 offset:4096
    v_mfma_f32_16x16x32_bf16 v[96:99], a[28:31], v[156:159], v[96:99]
    ds_read_b64_tr_b16 a[70:71], v45 offset:4096
    v_mfma_f32_16x16x32_bf16 v[100:103], a[32:35], v[144:147], v[120:123]
    buffer_load_dwordx4 v13, s[12:15], s25 offen offset:1024 nt lds
    v_mfma_f32_16x16x32_bf16 v[100:103], a[36:39], v[148:151], v[100:103]
    ds_read_b64_tr_b16 a[62:63], v43 offset:4096
    v_mfma_f32_16x16x32_bf16 v[100:103], a[40:43], v[152:155], v[100:103]
    ds_read_b64_tr_b16 a[48:49], v40
    v_mfma_f32_16x16x32_bf16 v[100:103], a[44:47], v[156:159], v[100:103]
    v_exp_f32 v96, v96
    v_mfma_f32_16x16x32_bf16 v[104:107], a[16:19], v[160:163], v[124:127]
    buffer_load_dwordx4 v14, s[12:15], s25 offen offset:2048 nt lds
    v_mfma_f32_16x16x32_bf16 v[104:107], a[20:23], v[164:167], v[104:107]
    v_exp_f32 v97, v97
    v_mfma_f32_16x16x32_bf16 v[104:107], a[24:27], v[168:171], v[104:107]
    ds_read_b128 a[16:19], v24
    v_cvt_pk_bf16_f32 v60, v96, v97
    v_mfma_f32_16x16x32_bf16 v[104:107], a[28:31], v[172:175], v[104:107]
    v_exp_f32 v98, v98
    v_mfma_f32_16x16x32_bf16 v[108:111], a[32:35], v[160:163], v[124:127]
    ds_read_b128 a[20:23], v25
    v_mfma_f32_16x16x32_bf16 v[108:111], a[36:39], v[164:167], v[108:111]
    v_exp_f32 v99, v99
    v_mfma_f32_16x16x32_bf16 v[108:111], a[40:43], v[168:171], v[108:111]
    ds_read_b128 a[24:27], v26
    v_cvt_pk_bf16_f32 v61, v98, v99
    v_mfma_f32_16x16x32_bf16 v[108:111], a[44:47], v[172:175], v[108:111]
    s_waitcnt lgkmcnt(3)
    v_exp_f32 v100, v100
    v_mfma_f32_16x16x32_bf16 v[176:179], a[48:51], v[48:51], v[176:179]
    buffer_load_dwordx4 v15, s[12:15], s25 offen offset:3072 nt lds
    v_mfma_f32_16x16x32_bf16 v[180:183], a[52:55], v[48:51], v[180:183]
    v_exp_f32 v101, v101
    v_mfma_f32_16x16x32_bf16 v[208:211], a[48:51], v[52:55], v[208:211]
    ds_read_b128 a[28:31], v27
    v_cvt_pk_bf16_f32 v62, v100, v101
    v_mfma_f32_16x16x32_bf16 v[212:215], a[52:55], v[52:55], v[212:215]
    v_exp_f32 v102, v102
    v_mfma_f32_16x16x32_bf16 v[184:187], a[56:59], v[48:51], v[184:187]
    ds_read_b128 a[32:35], v24 offset:4096
    ds_read_b128 a[44:47], v27 offset:4096
    v_mfma_f32_16x16x32_bf16 v[188:191], a[60:63], v[48:51], v[188:191]
    v_exp_f32 v103, v103
    v_mfma_f32_16x16x32_bf16 v[216:219], a[56:59], v[52:55], v[216:219]
    ds_read_b128 a[36:39], v25 offset:4096
    v_cvt_pk_bf16_f32 v63, v102, v103
    v_mfma_f32_16x16x32_bf16 v[220:223], a[60:63], v[52:55], v[220:223]
    s_max_u32 m0, s45, s34
    v_exp_f32 v104, v104
    v_mfma_f32_16x16x32_bf16 v[192:195], a[64:67], v[48:51], v[192:195]
    buffer_load_dwordx4 v12, s[12:15], s26 offen nt lds
    v_mfma_f32_16x16x32_bf16 v[196:199], a[68:71], v[48:51], v[196:199]
    v_exp_f32 v105, v105
    v_mfma_f32_16x16x32_bf16 v[224:227], a[64:67], v[52:55], v[224:227]
    ds_read_b128 a[40:43], v26 offset:4096
    v_cvt_pk_bf16_f32 v64, v104, v105
    v_mfma_f32_16x16x32_bf16 v[228:231], a[68:71], v[52:55], v[228:231]
    v_exp_f32 v106, v106
    v_mfma_f32_16x16x32_bf16 v[200:203], a[72:75], v[48:51], v[200:203]
    ds_read_b64_tr_b16 a[56:57], v42 offset:8192
    ds_read_b64_tr_b16 a[70:71], v45 offset:12288
    v_mfma_f32_16x16x32_bf16 v[204:207], a[76:79], v[48:51], v[204:207]
    v_exp_f32 v107, v107
    v_mfma_f32_16x16x32_bf16 v[232:235], a[72:75], v[52:55], v[232:235]
    ds_read_b64_tr_b16 a[72:73], v46 offset:8192
    v_cvt_pk_bf16_f32 v65, v106, v107
    v_mfma_f32_16x16x32_bf16 v[236:239], a[76:79], v[52:55], v[236:239]
    v_exp_f32 v108, v108
    v_mfma_f32_16x16x32_bf16 a[96:99], a[108:111], v[48:51], a[96:99]
    buffer_load_dwordx4 v13, s[12:15], s26 offen offset:1024 nt lds
    v_mfma_f32_16x16x32_bf16 a[100:103], a[108:111], v[52:55], a[100:103]
    s_waitcnt lgkmcnt(3)
    v_exp_f32 v109, v109
    v_mfma_f32_16x16x32_bf16 v[72:75], a[16:19], v[144:147], v[120:123]
    ds_read_b64_tr_b16 a[76:77], v47 offset:8192
    v_cvt_pk_bf16_f32 v66, v108, v109
    v_mfma_f32_16x16x32_bf16 v[72:75], a[20:23], v[148:151], v[72:75]
    v_exp_f32 v110, v110
    v_mfma_f32_16x16x32_bf16 v[72:75], a[24:27], v[152:155], v[72:75]
    ds_read_b64_tr_b16 a[58:59], v42 offset:12288
    ds_read_b64_tr_b16 a[78:79], v47 offset:12288
    v_mfma_f32_16x16x32_bf16 v[72:75], a[28:31], v[156:159], v[72:75]
    v_exp_f32 v111, v111
    v_mfma_f32_16x16x32_bf16 v[76:79], a[32:35], v[144:147], v[120:123]
    ds_read_b64_tr_b16 a[74:75], v46 offset:12288
    v_cvt_pk_bf16_f32 v67, v110, v111
    v_mfma_f32_16x16x32_bf16 v[76:79], a[36:39], v[148:151], v[76:79]
    ds_read_b64_tr_b16 a[48:49], v40 offset:8192
    ds_read_b64_tr_b16 a[60:61], v43 offset:8192
    v_mfma_f32_16x16x32_bf16 v[76:79], a[40:43], v[152:155], v[76:79]
    buffer_load_dwordx4 v14, s[12:15], s26 offen offset:2048 nt lds
    v_mfma_f32_16x16x32_bf16 v[76:79], a[44:47], v[156:159], v[76:79]
    v_exp_f32 v72, v72
    v_mfma_f32_16x16x32_bf16 v[80:83], a[16:19], v[160:163], v[124:127]
    ds_read_b64_tr_b16 a[50:51], v40 offset:12288
    ds_read_b64_tr_b16 a[62:63], v43 offset:12288
    v_mfma_f32_16x16x32_bf16 v[80:83], a[20:23], v[164:167], v[80:83]
    v_exp_f32 v73, v73
    v_mfma_f32_16x16x32_bf16 v[80:83], a[24:27], v[168:171], v[80:83]
    ds_read_b64_tr_b16 a[52:53], v41 offset:8192
    v_cvt_pk_bf16_f32 v48, v72, v73
    v_mfma_f32_16x16x32_bf16 v[80:83], a[28:31], v[172:175], v[80:83]
    v_exp_f32 v74, v74
    v_mfma_f32_16x16x32_bf16 v[84:87], a[32:35], v[160:163], v[124:127]
    buffer_load_dwordx4 v15, s[12:15], s26 offen offset:3072 nt lds
    v_mfma_f32_16x16x32_bf16 v[84:87], a[36:39], v[164:167], v[84:87]
    v_exp_f32 v75, v75
    v_mfma_f32_16x16x32_bf16 v[84:87], a[40:43], v[168:171], v[84:87]
    ds_read_b64_tr_b16 a[54:55], v41 offset:12288
    v_cvt_pk_bf16_f32 v49, v74, v75
    v_mfma_f32_16x16x32_bf16 v[84:87], a[44:47], v[172:175], v[84:87]
    v_exp_f32 v76, v76
    v_mfma_f32_16x16x32_bf16 v[88:91], a[16:19], a[0:3], v[128:131]
    ds_read_b64_tr_b16 a[64:65], v44 offset:8192
    ds_read_b128 a[16:19], v24 offset:8192
    v_mfma_f32_16x16x32_bf16 v[88:91], a[20:23], a[4:7], v[88:91]
    v_exp_f32 v77, v77
    v_mfma_f32_16x16x32_bf16 v[88:91], a[24:27], a[8:11], v[88:91]
    ds_read_b128 a[20:23], v25 offset:8192
    v_cvt_pk_bf16_f32 v50, v76, v77
    v_mfma_f32_16x16x32_bf16 v[88:91], a[28:31], a[12:15], v[88:91]
    v_exp_f32 v78, v78
    v_mfma_f32_16x16x32_bf16 v[92:95], a[32:35], a[0:3], v[128:131]
    ds_read_b64_tr_b16 a[66:67], v44 offset:12288
    ds_read_b128 a[24:27], v26 offset:8192
    v_mfma_f32_16x16x32_bf16 v[92:95], a[36:39], a[4:7], v[92:95]
    v_exp_f32 v79, v79
    v_mfma_f32_16x16x32_bf16 v[92:95], a[40:43], a[8:11], v[92:95]
    ds_read_b128 a[28:31], v27 offset:8192
    v_cvt_pk_bf16_f32 v51, v78, v79
    v_mfma_f32_16x16x32_bf16 v[92:95], a[44:47], a[12:15], v[92:95]
    s_waitcnt lgkmcnt(4)
    v_exp_f32 v80, v80
    v_mfma_f32_16x16x32_bf16 v[176:179], a[48:51], v[60:63], v[176:179]
    ds_read_b64_tr_b16 a[68:69], v45 offset:8192
    ds_read_b128 a[32:35], v24 offset:12288
    v_mfma_f32_16x16x32_bf16 v[180:183], a[52:55], v[60:63], v[180:183]
    v_exp_f32 v81, v81
    v_mfma_f32_16x16x32_bf16 v[208:211], a[48:51], v[64:67], v[208:211]
    ds_read_b128 a[36:39], v25 offset:12288
    v_cvt_pk_bf16_f32 v52, v80, v81
    v_mfma_f32_16x16x32_bf16 v[212:215], a[52:55], v[64:67], v[212:215]
    v_exp_f32 v82, v82
    v_mfma_f32_16x16x32_bf16 v[184:187], a[56:59], v[60:63], v[184:187]
    ds_read_b128 a[40:43], v26 offset:12288
    v_mfma_f32_16x16x32_bf16 v[188:191], a[60:63], v[60:63], v[188:191]
    v_exp_f32 v83, v83
    v_mfma_f32_16x16x32_bf16 v[216:219], a[56:59], v[64:67], v[216:219]
    ds_read_b128 a[44:47], v27 offset:12288
    v_cvt_pk_bf16_f32 v53, v82, v83
    v_mfma_f32_16x16x32_bf16 v[220:223], a[60:63], v[64:67], v[220:223]
    s_waitcnt lgkmcnt(3)
    v_exp_f32 v84, v84
    v_mfma_f32_16x16x32_bf16 v[192:195], a[64:67], v[60:63], v[192:195]
    v_mfma_f32_16x16x32_bf16 v[196:199], a[68:71], v[60:63], v[196:199]
    v_exp_f32 v85, v85
    v_mfma_f32_16x16x32_bf16 v[224:227], a[64:67], v[64:67], v[224:227]
    s_waitcnt vmcnt(8)
    s_barrier
    v_cvt_pk_bf16_f32 v54, v84, v85
    v_mfma_f32_16x16x32_bf16 v[228:231], a[68:71], v[64:67], v[228:231]
    s_max_u32 m0, s48, s34
    v_exp_f32 v86, v86
    v_mfma_f32_16x16x32_bf16 v[200:203], a[72:75], v[60:63], v[200:203]
    ds_read_b64_tr_b16 a[62:63], v35 offset:36864
    buffer_load_dwordx4 v16, s[16:19], s25 offen nt lds
    v_mfma_f32_16x16x32_bf16 v[204:207], a[76:79], v[60:63], v[204:207]
    v_exp_f32 v87, v87
    v_mfma_f32_16x16x32_bf16 v[232:235], a[72:75], v[64:67], v[232:235]
    ds_read_b64_tr_b16 a[60:61], v35 offset:32768
    v_cvt_pk_bf16_f32 v55, v86, v87
    v_mfma_f32_16x16x32_bf16 v[236:239], a[76:79], v[64:67], v[236:239]
    v_exp_f32 v88, v88
    v_mfma_f32_16x16x32_bf16 a[96:99], a[108:111], v[60:63], a[96:99]
    buffer_load_dwordx4 v17, s[16:19], s25 offen offset:1024 nt lds
    v_mfma_f32_16x16x32_bf16 a[100:103], a[108:111], v[64:67], a[100:103]
    v_exp_f32 v89, v89
    v_mfma_f32_16x16x32_bf16 v[96:99], a[16:19], v[144:147], v[120:123]
    ds_read_b64_tr_b16 a[58:59], v34 offset:36864
    v_cvt_pk_bf16_f32 v56, v88, v89
    v_mfma_f32_16x16x32_bf16 v[96:99], a[20:23], v[148:151], v[96:99]
    v_exp_f32 v90, v90
    v_mfma_f32_16x16x32_bf16 v[96:99], a[24:27], v[152:155], v[96:99]
    buffer_load_dwordx4 v16, s[16:19], s25 offen offset:2048 nt lds
    v_mfma_f32_16x16x32_bf16 v[96:99], a[28:31], v[156:159], v[96:99]
    v_exp_f32 v91, v91
    v_mfma_f32_16x16x32_bf16 v[100:103], a[32:35], v[144:147], v[120:123]
    s_waitcnt lgkmcnt(1)
    ds_read_b64_tr_b16 a[48:49], v32 offset:32768
    v_cvt_pk_bf16_f32 v57, v90, v91
    v_mfma_f32_16x16x32_bf16 v[100:103], a[36:39], v[148:151], v[100:103]
    v_exp_f32 v92, v92
    v_mfma_f32_16x16x32_bf16 v[100:103], a[40:43], v[152:155], v[100:103]
    buffer_load_dwordx4 v17, s[16:19], s25 offen offset:3072 nt lds
    v_mfma_f32_16x16x32_bf16 v[100:103], a[44:47], v[156:159], v[100:103]
    v_exp_f32 v93, v93
    v_mfma_f32_16x16x32_bf16 v[104:107], a[16:19], v[160:163], v[124:127]
    ds_read_b64_tr_b16 a[50:51], v32 offset:36864
    v_cvt_pk_bf16_f32 v58, v92, v93
    v_mfma_f32_16x16x32_bf16 v[104:107], a[20:23], v[164:167], v[104:107]
    s_max_u32 m0, s49, s34
    v_exp_f32 v94, v94
    v_mfma_f32_16x16x32_bf16 v[104:107], a[24:27], v[168:171], v[104:107]
    buffer_load_dwordx4 v16, s[16:19], s26 offen nt lds
    v_mfma_f32_16x16x32_bf16 v[104:107], a[28:31], v[172:175], v[104:107]
    v_exp_f32 v95, v95
    v_mfma_f32_16x16x32_bf16 v[108:111], a[32:35], v[160:163], v[124:127]
    ds_read_b64_tr_b16 a[52:53], v33 offset:32768
    v_cvt_pk_bf16_f32 v59, v94, v95
    v_mfma_f32_16x16x32_bf16 v[108:111], a[36:39], v[164:167], v[108:111]
    v_exp_f32 v96, v96
    v_mfma_f32_16x16x32_bf16 v[108:111], a[40:43], v[168:171], v[108:111]
    buffer_load_dwordx4 v17, s[16:19], s26 offen offset:1024 nt lds
    v_mfma_f32_16x16x32_bf16 v[108:111], a[44:47], v[172:175], v[108:111]
    v_exp_f32 v97, v97
    v_mfma_f32_16x16x32_bf16 v[112:115], a[16:19], a[0:3], v[128:131]
    ds_read_b64_tr_b16 a[54:55], v33 offset:36864
    v_cvt_pk_bf16_f32 v60, v96, v97
    v_mfma_f32_16x16x32_bf16 v[112:115], a[20:23], a[4:7], v[112:115]
    v_exp_f32 v98, v98
    v_mfma_f32_16x16x32_bf16 v[112:115], a[24:27], a[8:11], v[112:115]
    buffer_load_dwordx4 v16, s[16:19], s26 offen offset:2048 nt lds
    v_mfma_f32_16x16x32_bf16 v[112:115], a[28:31], a[12:15], v[112:115]
    v_exp_f32 v99, v99
    v_mfma_f32_16x16x32_bf16 v[116:119], a[32:35], a[0:3], v[128:131]
    ds_read_b64_tr_b16 a[56:57], v34 offset:32768
    v_cvt_pk_bf16_f32 v61, v98, v99
    v_mfma_f32_16x16x32_bf16 v[116:119], a[36:39], a[4:7], v[116:119]
    v_exp_f32 v100, v100
    v_mfma_f32_16x16x32_bf16 v[116:119], a[40:43], a[8:11], v[116:119]
    buffer_load_dwordx4 v17, s[16:19], s26 offen offset:3072 nt lds
    v_mfma_f32_16x16x32_bf16 v[116:119], a[44:47], a[12:15], v[116:119]
    s_waitcnt lgkmcnt(1)
    v_exp_f32 v101, v101
    v_mfma_f32_16x16x32_bf16 v[176:179], a[48:51], v[48:51], v[176:179]
    ds_read_b64_tr_b16 a[70:71], v37 offset:36864
    v_cvt_pk_bf16_f32 v62, v100, v101
    v_mfma_f32_16x16x32_bf16 v[180:183], a[52:55], v[48:51], v[180:183]
    v_exp_f32 v102, v102
    v_mfma_f32_16x16x32_bf16 v[208:211], a[48:51], v[52:55], v[208:211]
    ds_read_b64_tr_b16 a[64:65], v36 offset:32768
    ds_read_b64_tr_b16 a[68:69], v37 offset:32768
    v_mfma_f32_16x16x32_bf16 v[212:215], a[52:55], v[52:55], v[212:215]
    v_exp_f32 v103, v103
    v_mfma_f32_16x16x32_bf16 v[240:243], a[48:51], v[56:59], v[240:243]
    ds_read_b64_tr_b16 a[66:67], v36 offset:36864
    v_cvt_pk_bf16_f32 v63, v102, v103
    v_mfma_f32_16x16x32_bf16 v[244:247], a[52:55], v[56:59], v[244:247]
    s_waitcnt lgkmcnt(4)
    v_exp_f32 v104, v104
    v_mfma_f32_16x16x32_bf16 v[184:187], a[56:59], v[48:51], v[184:187]
    ds_read_b64_tr_b16 a[72:73], v38 offset:32768
    ds_read_b64_tr_b16 a[78:79], v39 offset:36864
    v_mfma_f32_16x16x32_bf16 v[188:191], a[60:63], v[48:51], v[188:191]
    v_exp_f32 v105, v105
    v_mfma_f32_16x16x32_bf16 v[216:219], a[56:59], v[52:55], v[216:219]
    ds_read_b64_tr_b16 a[76:77], v39 offset:32768
    v_cvt_pk_bf16_f32 v64, v104, v105
    v_mfma_f32_16x16x32_bf16 v[220:223], a[60:63], v[52:55], v[220:223]
    v_exp_f32 v106, v106
    v_mfma_f32_16x16x32_bf16 v[248:251], a[56:59], v[56:59], v[248:251]
    ds_read_b64_tr_b16 a[74:75], v38 offset:36864
    ds_read_b128 a[16:19], v28
    v_mfma_f32_16x16x32_bf16 v[252:255], a[60:63], v[56:59], v[252:255]
    s_waitcnt lgkmcnt(5)
    v_exp_f32 v107, v107
    v_mfma_f32_16x16x32_bf16 v[192:195], a[64:67], v[48:51], v[192:195]
    ds_read_b128 a[24:27], v30
    v_cvt_pk_bf16_f32 v65, v106, v107
    v_mfma_f32_16x16x32_bf16 v[196:199], a[68:71], v[48:51], v[196:199]
    v_exp_f32 v108, v108
    v_mfma_f32_16x16x32_bf16 v[224:227], a[64:67], v[52:55], v[224:227]
    ds_read_b128 a[20:23], v29
    ds_read_b128 a[36:39], v29 offset:4096
    v_mfma_f32_16x16x32_bf16 v[228:231], a[68:71], v[52:55], v[228:231]
    s_add_u32 s25, s25, 0x8000
    v_exp_f32 v109, v109
    v_mfma_f32_16x16x32_bf16 a[80:83], a[64:67], v[56:59], a[80:83]
    ds_read_b128 a[40:43], v30 offset:4096
    v_cvt_pk_bf16_f32 v66, v108, v109
    v_mfma_f32_16x16x32_bf16 a[84:87], a[68:71], v[56:59], a[84:87]
    s_waitcnt lgkmcnt(4)
    s_add_u32 s26, s26, 0x8000
    v_exp_f32 v110, v110
    v_mfma_f32_16x16x32_bf16 v[200:203], a[72:75], v[48:51], v[200:203]
    ds_read_b128 a[44:47], v31 offset:4096
    ds_read_b64_tr_b16 a[70:71], v37 offset:45056
    v_mfma_f32_16x16x32_bf16 v[204:207], a[76:79], v[48:51], v[204:207]
    s_cmp_ge_u32 s25, 0x40000
    v_exp_f32 v111, v111
    v_mfma_f32_16x16x32_bf16 v[232:235], a[72:75], v[52:55], v[232:235]
    ds_read_b128 a[28:31], v31
    v_cvt_pk_bf16_f32 v67, v110, v111
    v_mfma_f32_16x16x32_bf16 v[236:239], a[76:79], v[52:55], v[236:239]
    s_cselect_b32 s34, 0x30000, 0
    v_exp_f32 v112, v112
    v_mfma_f32_16x16x32_bf16 a[88:91], a[72:75], v[56:59], a[88:91]
    ds_read_b128 a[32:35], v28 offset:4096
    ds_read_b64_tr_b16 a[72:73], v38 offset:40960
    v_mfma_f32_16x16x32_bf16 a[92:95], a[76:79], v[56:59], a[92:95]
    v_exp_f32 v113, v113
    v_mfma_f32_16x16x32_bf16 a[96:99], a[108:111], v[48:51], a[96:99]
    ds_read_b64_tr_b16 a[48:49], v32 offset:40960
    v_cvt_pk_bf16_f32 v68, v112, v113
    v_mfma_f32_16x16x32_bf16 a[100:103], a[108:111], v[52:55], a[100:103]
    v_exp_f32 v114, v114
    v_mfma_f32_16x16x32_bf16 a[104:107], a[108:111], v[56:59], a[104:107]
    ds_read_b64_tr_b16 a[50:51], v32 offset:45056
    ds_read_b64_tr_b16 a[68:69], v37 offset:40960
    v_mfma_f32_16x16x32_bf16 v[72:75], a[16:19], v[144:147], v[120:123]
    s_waitcnt lgkmcnt(5)
    v_exp_f32 v115, v115
    v_mfma_f32_16x16x32_bf16 v[72:75], a[20:23], v[148:151], v[72:75]
    ds_read_b64_tr_b16 a[52:53], v33 offset:40960
    v_cvt_pk_bf16_f32 v69, v114, v115
    v_mfma_f32_16x16x32_bf16 v[72:75], a[24:27], v[152:155], v[72:75]
    v_exp_f32 v116, v116
    v_mfma_f32_16x16x32_bf16 v[72:75], a[28:31], v[156:159], v[72:75]
    s_waitcnt lgkmcnt(3)
    ds_read_b64_tr_b16 a[54:55], v33 offset:45056
    ds_read_b64_tr_b16 a[74:75], v38 offset:45056
    v_mfma_f32_16x16x32_bf16 v[76:79], a[32:35], v[144:147], v[120:123]
    v_exp_f32 v117, v117
    v_mfma_f32_16x16x32_bf16 v[76:79], a[36:39], v[148:151], v[76:79]
    ds_read_b64_tr_b16 a[58:59], v34 offset:45056
    v_cvt_pk_bf16_f32 v70, v116, v117
    v_mfma_f32_16x16x32_bf16 v[76:79], a[40:43], v[152:155], v[76:79]
    v_exp_f32 v118, v118
    v_mfma_f32_16x16x32_bf16 v[76:79], a[44:47], v[156:159], v[76:79]
    ds_read_b64_tr_b16 a[62:63], v35 offset:45056
    ds_read_b64_tr_b16 a[78:79], v39 offset:45056
    v_mfma_f32_16x16x32_bf16 v[80:83], a[16:19], v[160:163], v[124:127]
    v_exp_f32 v119, v119
    v_mfma_f32_16x16x32_bf16 v[80:83], a[20:23], v[164:167], v[80:83]
    ds_read_b64_tr_b16 a[66:67], v36 offset:45056
    v_cvt_pk_bf16_f32 v71, v118, v119
    v_mfma_f32_16x16x32_bf16 v[80:83], a[24:27], v[168:171], v[80:83]
    v_exp_f32 v72, v72
    v_mfma_f32_16x16x32_bf16 v[80:83], a[28:31], v[172:175], v[80:83]
    ds_read_b64_tr_b16 a[56:57], v34 offset:40960
    ds_read_b128 a[20:23], v29 offset:8192
    v_mfma_f32_16x16x32_bf16 v[84:87], a[32:35], v[160:163], v[124:127]
    v_exp_f32 v73, v73
    v_mfma_f32_16x16x32_bf16 v[84:87], a[36:39], v[164:167], v[84:87]
    ds_read_b128 a[28:31], v31 offset:8192
    v_cvt_pk_bf16_f32 v48, v72, v73
    v_mfma_f32_16x16x32_bf16 v[84:87], a[40:43], v[168:171], v[84:87]
    v_exp_f32 v74, v74
    v_mfma_f32_16x16x32_bf16 v[84:87], a[44:47], v[172:175], v[84:87]
    s_waitcnt lgkmcnt(3)
    ds_read_b64_tr_b16 a[60:61], v35 offset:40960
    ds_read_b128 a[36:39], v29 offset:12288
    v_mfma_f32_16x16x32_bf16 v[176:179], a[48:51], v[60:63], v[176:179]
    v_exp_f32 v75, v75
    v_mfma_f32_16x16x32_bf16 v[180:183], a[52:55], v[60:63], v[180:183]
    ds_read_b128 a[44:47], v31 offset:12288
    v_cvt_pk_bf16_f32 v49, v74, v75
    v_mfma_f32_16x16x32_bf16 v[208:211], a[48:51], v[64:67], v[208:211]
    v_exp_f32 v76, v76
    v_mfma_f32_16x16x32_bf16 v[212:215], a[52:55], v[64:67], v[212:215]
    ds_read_b64_tr_b16 a[64:65], v36 offset:40960
    ds_read_b128 a[40:43], v30 offset:12288
    v_mfma_f32_16x16x32_bf16 v[240:243], a[48:51], v[68:71], v[240:243]
    v_exp_f32 v77, v77
    v_mfma_f32_16x16x32_bf16 v[244:247], a[52:55], v[68:71], v[244:247]
    s_waitcnt lgkmcnt(3)
    ds_read_b128 a[32:35], v28 offset:12288
    v_cvt_pk_bf16_f32 v50, v76, v77
    v_mfma_f32_16x16x32_bf16 v[184:187], a[56:59], v[60:63], v[184:187]
    v_exp_f32 v78, v78
    v_mfma_f32_16x16x32_bf16 v[188:191], a[60:63], v[60:63], v[188:191]
    ds_read_b128 a[24:27], v30 offset:8192
    ds_read_b64_tr_b16 a[50:51], v40 offset:36864
    v_mfma_f32_16x16x32_bf16 v[216:219], a[56:59], v[64:67], v[216:219]
    v_exp_f32 v79, v79
    v_mfma_f32_16x16x32_bf16 v[220:223], a[60:63], v[64:67], v[220:223]
    ds_read_b128 a[16:19], v28 offset:8192
    v_cvt_pk_bf16_f32 v51, v78, v79
    v_mfma_f32_16x16x32_bf16 v[248:251], a[56:59], v[68:71], v[248:251]
    v_exp_f32 v80, v80
    v_mfma_f32_16x16x32_bf16 v[252:255], a[60:63], v[68:71], v[252:255]
    s_waitcnt lgkmcnt(3)
    ds_read_b64_tr_b16 a[76:77], v39 offset:40960
    ds_read_b64_tr_b16 a[52:53], v41 offset:32768
    v_mfma_f32_16x16x32_bf16 v[192:195], a[64:67], v[60:63], v[192:195]
    v_exp_f32 v81, v81
    v_mfma_f32_16x16x32_bf16 v[196:199], a[68:71], v[60:63], v[196:199]
    ds_read_b64_tr_b16 a[58:59], v42 offset:36864
    v_cvt_pk_bf16_f32 v52, v80, v81
    v_mfma_f32_16x16x32_bf16 v[224:227], a[64:67], v[64:67], v[224:227]
    v_exp_f32 v82, v82
    v_mfma_f32_16x16x32_bf16 v[228:231], a[68:71], v[64:67], v[228:231]
    ds_read_b64_tr_b16 a[54:55], v41 offset:36864
    ds_read_b64_tr_b16 a[60:61], v43 offset:32768
    v_mfma_f32_16x16x32_bf16 a[80:83], a[64:67], v[68:71], a[80:83]
    v_exp_f32 v83, v83
    v_mfma_f32_16x16x32_bf16 a[84:87], a[68:71], v[68:71], a[84:87]
    ds_read_b64_tr_b16 a[64:65], v44 offset:32768
    v_cvt_pk_bf16_f32 v53, v82, v83
    v_mfma_f32_16x16x32_bf16 v[200:203], a[72:75], v[60:63], v[200:203]
    s_waitcnt lgkmcnt(4)
    v_exp_f32 v84, v84
    v_mfma_f32_16x16x32_bf16 v[204:207], a[76:79], v[60:63], v[204:207]
    ds_read_b64_tr_b16 a[56:57], v42 offset:32768
    ds_read_b64_tr_b16 a[66:67], v44 offset:36864
    v_mfma_f32_16x16x32_bf16 v[232:235], a[72:75], v[64:67], v[232:235]
    v_exp_f32 v85, v85
    v_mfma_f32_16x16x32_bf16 v[236:239], a[76:79], v[64:67], v[236:239]
    ds_read_b64_tr_b16 a[68:69], v45 offset:32768
    v_cvt_pk_bf16_f32 v54, v84, v85
    v_mfma_f32_16x16x32_bf16 a[88:91], a[72:75], v[68:71], a[88:91]
    v_exp_f32 v86, v86
    v_mfma_f32_16x16x32_bf16 a[92:95], a[76:79], v[68:71], a[92:95]
    s_waitcnt vmcnt(8)
    s_barrier
    v_mfma_f32_16x16x32_bf16 a[96:99], a[108:111], v[60:63], a[96:99]
    v_exp_f32 v87, v87
    v_mfma_f32_16x16x32_bf16 a[100:103], a[108:111], v[64:67], a[100:103]
    ds_read_b64_tr_b16 a[72:73], v46 offset:32768
    v_cvt_pk_bf16_f32 v55, v86, v87
    v_mfma_f32_16x16x32_bf16 a[104:107], a[108:111], v[68:71], a[104:107]
    s_max_u32 m0, s46, s34
    ds_read_b64_tr_b16 a[74:75], v46 offset:36864
    v_mfma_f32_16x16x32_bf16 v[96:99], a[16:19], v[144:147], v[120:123]
    buffer_load_dwordx4 v12, s[12:15], s25 offen nt lds
    v_mfma_f32_16x16x32_bf16 v[96:99], a[20:23], v[148:151], v[96:99]
    ds_read_b64_tr_b16 a[76:77], v47 offset:32768
    v_mfma_f32_16x16x32_bf16 v[96:99], a[24:27], v[152:155], v[96:99]
    ds_read_b64_tr_b16 a[78:79], v47 offset:36864
    v_mfma_f32_16x16x32_bf16 v[96:99], a[28:31], v[156:159], v[96:99]
    ds_read_b64_tr_b16 a[70:71], v45 offset:36864
    v_mfma_f32_16x16x32_bf16 v[100:103], a[32:35], v[144:147], v[120:123]
    buffer_load_dwordx4 v13, s[12:15], s25 offen offset:1024 nt lds
    v_mfma_f32_16x16x32_bf16 v[100:103], a[36:39], v[148:151], v[100:103]
    ds_read_b64_tr_b16 a[62:63], v43 offset:36864
    v_mfma_f32_16x16x32_bf16 v[100:103], a[40:43], v[152:155], v[100:103]
    ds_read_b64_tr_b16 a[48:49], v40 offset:32768
    v_mfma_f32_16x16x32_bf16 v[100:103], a[44:47], v[156:159], v[100:103]
    v_exp_f32 v96, v96
    v_mfma_f32_16x16x32_bf16 v[104:107], a[16:19], v[160:163], v[124:127]
    buffer_load_dwordx4 v14, s[12:15], s25 offen offset:2048 nt lds
    v_mfma_f32_16x16x32_bf16 v[104:107], a[20:23], v[164:167], v[104:107]
    v_exp_f32 v97, v97
    v_mfma_f32_16x16x32_bf16 v[104:107], a[24:27], v[168:171], v[104:107]
    ds_read_b128 a[16:19], v24 offset:32768
    v_cvt_pk_bf16_f32 v60, v96, v97
    v_mfma_f32_16x16x32_bf16 v[104:107], a[28:31], v[172:175], v[104:107]
    v_exp_f32 v98, v98
    v_mfma_f32_16x16x32_bf16 v[108:111], a[32:35], v[160:163], v[124:127]
    ds_read_b128 a[20:23], v25 offset:32768
    v_mfma_f32_16x16x32_bf16 v[108:111], a[36:39], v[164:167], v[108:111]
    v_exp_f32 v99, v99
    v_mfma_f32_16x16x32_bf16 v[108:111], a[40:43], v[168:171], v[108:111]
    ds_read_b128 a[24:27], v26 offset:32768
    v_cvt_pk_bf16_f32 v61, v98, v99
    v_mfma_f32_16x16x32_bf16 v[108:111], a[44:47], v[172:175], v[108:111]
    s_waitcnt lgkmcnt(3)
    v_exp_f32 v100, v100
    v_mfma_f32_16x16x32_bf16 v[176:179], a[48:51], v[48:51], v[176:179]
    buffer_load_dwordx4 v15, s[12:15], s25 offen offset:3072 nt lds
    v_mfma_f32_16x16x32_bf16 v[180:183], a[52:55], v[48:51], v[180:183]
    v_exp_f32 v101, v101
    v_mfma_f32_16x16x32_bf16 v[208:211], a[48:51], v[52:55], v[208:211]
    ds_read_b128 a[28:31], v27 offset:32768
    v_cvt_pk_bf16_f32 v62, v100, v101
    v_mfma_f32_16x16x32_bf16 v[212:215], a[52:55], v[52:55], v[212:215]
    v_exp_f32 v102, v102
    v_mfma_f32_16x16x32_bf16 v[184:187], a[56:59], v[48:51], v[184:187]
    ds_read_b128 a[32:35], v24 offset:36864
    ds_read_b128 a[44:47], v27 offset:36864
    v_mfma_f32_16x16x32_bf16 v[188:191], a[60:63], v[48:51], v[188:191]
    v_exp_f32 v103, v103
    v_mfma_f32_16x16x32_bf16 v[216:219], a[56:59], v[52:55], v[216:219]
    ds_read_b128 a[36:39], v25 offset:36864
    v_cvt_pk_bf16_f32 v63, v102, v103
    v_mfma_f32_16x16x32_bf16 v[220:223], a[60:63], v[52:55], v[220:223]
    s_max_u32 m0, s47, s34
    v_exp_f32 v104, v104
    v_mfma_f32_16x16x32_bf16 v[192:195], a[64:67], v[48:51], v[192:195]
    buffer_load_dwordx4 v12, s[12:15], s26 offen nt lds
    v_mfma_f32_16x16x32_bf16 v[196:199], a[68:71], v[48:51], v[196:199]
    v_exp_f32 v105, v105
    v_mfma_f32_16x16x32_bf16 v[224:227], a[64:67], v[52:55], v[224:227]
    ds_read_b128 a[40:43], v26 offset:36864
    v_cvt_pk_bf16_f32 v64, v104, v105
    v_mfma_f32_16x16x32_bf16 v[228:231], a[68:71], v[52:55], v[228:231]
    v_exp_f32 v106, v106
    v_mfma_f32_16x16x32_bf16 v[200:203], a[72:75], v[48:51], v[200:203]
    ds_read_b64_tr_b16 a[56:57], v42 offset:40960
    ds_read_b64_tr_b16 a[70:71], v45 offset:45056
    v_mfma_f32_16x16x32_bf16 v[204:207], a[76:79], v[48:51], v[204:207]
    v_exp_f32 v107, v107
    v_mfma_f32_16x16x32_bf16 v[232:235], a[72:75], v[52:55], v[232:235]
    ds_read_b64_tr_b16 a[72:73], v46 offset:40960
    v_cvt_pk_bf16_f32 v65, v106, v107
    v_mfma_f32_16x16x32_bf16 v[236:239], a[76:79], v[52:55], v[236:239]
    s_cmp_eq_u32 s25, 0x48000
    v_exp_f32 v108, v108
    v_mfma_f32_16x16x32_bf16 a[96:99], a[108:111], v[48:51], a[96:99]
    buffer_load_dwordx4 v13, s[12:15], s26 offen offset:1024 nt lds
    v_mfma_f32_16x16x32_bf16 a[100:103], a[108:111], v[52:55], a[100:103]
    s_waitcnt lgkmcnt(3)
    s_cbranch_scc1 L_exit
    v_exp_f32 v109, v109
    v_mfma_f32_16x16x32_bf16 v[72:75], a[16:19], v[144:147], v[120:123]
    ds_read_b64_tr_b16 a[76:77], v47 offset:40960
    v_cvt_pk_bf16_f32 v66, v108, v109
    v_mfma_f32_16x16x32_bf16 v[72:75], a[20:23], v[148:151], v[72:75]
    v_exp_f32 v110, v110
    v_mfma_f32_16x16x32_bf16 v[72:75], a[24:27], v[152:155], v[72:75]
    ds_read_b64_tr_b16 a[58:59], v42 offset:45056
    ds_read_b64_tr_b16 a[78:79], v47 offset:45056
    v_mfma_f32_16x16x32_bf16 v[72:75], a[28:31], v[156:159], v[72:75]
    v_exp_f32 v111, v111
    v_mfma_f32_16x16x32_bf16 v[76:79], a[32:35], v[144:147], v[120:123]
    ds_read_b64_tr_b16 a[74:75], v46 offset:45056
    v_cvt_pk_bf16_f32 v67, v110, v111
    v_mfma_f32_16x16x32_bf16 v[76:79], a[36:39], v[148:151], v[76:79]
    ds_read_b64_tr_b16 a[48:49], v40 offset:40960
    ds_read_b64_tr_b16 a[60:61], v43 offset:40960
    v_mfma_f32_16x16x32_bf16 v[76:79], a[40:43], v[152:155], v[76:79]
    buffer_load_dwordx4 v14, s[12:15], s26 offen offset:2048 nt lds
    v_mfma_f32_16x16x32_bf16 v[76:79], a[44:47], v[156:159], v[76:79]
    v_exp_f32 v72, v72
    v_mfma_f32_16x16x32_bf16 v[80:83], a[16:19], v[160:163], v[124:127]
    ds_read_b64_tr_b16 a[50:51], v40 offset:45056
    ds_read_b64_tr_b16 a[62:63], v43 offset:45056
    v_mfma_f32_16x16x32_bf16 v[80:83], a[20:23], v[164:167], v[80:83]
    v_exp_f32 v73, v73
    v_mfma_f32_16x16x32_bf16 v[80:83], a[24:27], v[168:171], v[80:83]
    ds_read_b64_tr_b16 a[52:53], v41 offset:40960
    v_cvt_pk_bf16_f32 v48, v72, v73
    v_mfma_f32_16x16x32_bf16 v[80:83], a[28:31], v[172:175], v[80:83]
    v_exp_f32 v74, v74
    v_mfma_f32_16x16x32_bf16 v[84:87], a[32:35], v[160:163], v[124:127]
    buffer_load_dwordx4 v15, s[12:15], s26 offen offset:3072 nt lds
    v_mfma_f32_16x16x32_bf16 v[84:87], a[36:39], v[164:167], v[84:87]
    v_exp_f32 v75, v75
    v_mfma_f32_16x16x32_bf16 v[84:87], a[40:43], v[168:171], v[84:87]
    ds_read_b64_tr_b16 a[54:55], v41 offset:45056
    v_cvt_pk_bf16_f32 v49, v74, v75
    v_mfma_f32_16x16x32_bf16 v[84:87], a[44:47], v[172:175], v[84:87]
    v_exp_f32 v76, v76
    v_mfma_f32_16x16x32_bf16 v[88:91], a[16:19], a[0:3], v[128:131]
    ds_read_b64_tr_b16 a[64:65], v44 offset:40960
    ds_read_b128 a[16:19], v24 offset:40960
    v_mfma_f32_16x16x32_bf16 v[88:91], a[20:23], a[4:7], v[88:91]
    v_exp_f32 v77, v77
    v_mfma_f32_16x16x32_bf16 v[88:91], a[24:27], a[8:11], v[88:91]
    ds_read_b128 a[20:23], v25 offset:40960
    v_cvt_pk_bf16_f32 v50, v76, v77
    v_mfma_f32_16x16x32_bf16 v[88:91], a[28:31], a[12:15], v[88:91]
    v_exp_f32 v78, v78
    v_mfma_f32_16x16x32_bf16 v[92:95], a[32:35], a[0:3], v[128:131]
    ds_read_b64_tr_b16 a[66:67], v44 offset:45056
    ds_read_b128 a[24:27], v26 offset:40960
    v_mfma_f32_16x16x32_bf16 v[92:95], a[36:39], a[4:7], v[92:95]
    v_exp_f32 v79, v79
    v_mfma_f32_16x16x32_bf16 v[92:95], a[40:43], a[8:11], v[92:95]
    ds_read_b128 a[28:31], v27 offset:40960
    v_cvt_pk_bf16_f32 v51, v78, v79
    v_mfma_f32_16x16x32_bf16 v[92:95], a[44:47], a[12:15], v[92:95]
    s_waitcnt lgkmcnt(4)
    v_exp_f32 v80, v80
    v_mfma_f32_16x16x32_bf16 v[176:179], a[48:51], v[60:63], v[176:179]
    ds_read_b64_tr_b16 a[68:69], v45 offset:40960
    ds_read_b128 a[32:35], v24 offset:45056
    v_mfma_f32_16x16x32_bf16 v[180:183], a[52:55], v[60:63], v[180:183]
    v_exp_f32 v81, v81
    v_mfma_f32_16x16x32_bf16 v[208:211], a[48:51], v[64:67], v[208:211]
    ds_read_b128 a[36:39], v25 offset:45056
    v_cvt_pk_bf16_f32 v52, v80, v81
    v_mfma_f32_16x16x32_bf16 v[212:215], a[52:55], v[64:67], v[212:215]
    v_exp_f32 v82, v82
    v_mfma_f32_16x16x32_bf16 v[184:187], a[56:59], v[60:63], v[184:187]
    ds_read_b128 a[40:43], v26 offset:45056
    v_mfma_f32_16x16x32_bf16 v[188:191], a[60:63], v[60:63], v[188:191]
    v_exp_f32 v83, v83
    v_mfma_f32_16x16x32_bf16 v[216:219], a[56:59], v[64:67], v[216:219]
    ds_read_b128 a[44:47], v27 offset:45056
    v_cvt_pk_bf16_f32 v53, v82, v83
    v_mfma_f32_16x16x32_bf16 v[220:223], a[60:63], v[64:67], v[220:223]
    s_waitcnt lgkmcnt(3)
    v_exp_f32 v84, v84
    v_mfma_f32_16x16x32_bf16 v[192:195], a[64:67], v[60:63], v[192:195]
    v_mfma_f32_16x16x32_bf16 v[196:199], a[68:71], v[60:63], v[196:199]
    v_exp_f32 v85, v85
    v_mfma_f32_16x16x32_bf16 v[224:227], a[64:67], v[64:67], v[224:227]
    s_waitcnt vmcnt(8)
    s_barrier
    v_cvt_pk_bf16_f32 v54, v84, v85
    v_mfma_f32_16x16x32_bf16 v[228:231], a[68:71], v[64:67], v[228:231]
    s_max_u32 m0, s50, s34
    v_exp_f32 v86, v86
    v_mfma_f32_16x16x32_bf16 v[200:203], a[72:75], v[60:63], v[200:203]
    ds_read_b64_tr_b16 a[62:63], v35 offset:4096
    buffer_load_dwordx4 v16, s[16:19], s25 offen nt lds
    v_mfma_f32_16x16x32_bf16 v[204:207], a[76:79], v[60:63], v[204:207]
    v_exp_f32 v87, v87
    v_mfma_f32_16x16x32_bf16 v[232:235], a[72:75], v[64:67], v[232:235]
    ds_read_b64_tr_b16 a[60:61], v35
    v_cvt_pk_bf16_f32 v55, v86, v87
    v_mfma_f32_16x16x32_bf16 v[236:239], a[76:79], v[64:67], v[236:239]
    v_exp_f32 v88, v88
    v_mfma_f32_16x16x32_bf16 a[96:99], a[108:111], v[60:63], a[96:99]
    buffer_load_dwordx4 v17, s[16:19], s25 offen offset:1024 nt lds
    v_mfma_f32_16x16x32_bf16 a[100:103], a[108:111], v[64:67], a[100:103]
    s_branch L_loop
L_exit:
    ds_read_b64_tr_b16 a[48:49], v40 offset:40960
    ds_read_b64_tr_b16 a[50:51], v40 offset:45056
    ds_read_b64_tr_b16 a[52:53], v41 offset:40960
    ds_read_b64_tr_b16 a[54:55], v41 offset:45056
    ds_read_b64_tr_b16 a[58:59], v42 offset:45056
    ds_read_b64_tr_b16 a[60:61], v43 offset:40960
    ds_read_b64_tr_b16 a[62:63], v43 offset:45056
    ds_read_b64_tr_b16 a[64:65], v44 offset:40960
    v_mfma_f32_16x16x32_bf16 a[96:99], a[108:111], v[60:63], a[96:99]
    ds_read_b64_tr_b16 a[66:67], v44 offset:45056
    ds_read_b64_tr_b16 a[68:69], v45 offset:40960
    s_waitcnt lgkmcnt(10)
    s_waitcnt lgkmcnt(8)
    v_mfma_f32_16x16x32_bf16 v[176:179], a[48:51], v[60:63], v[176:179]
    v_exp_f32 v109, v109
    s_waitcnt lgkmcnt(6)
    v_mfma_f32_16x16x32_bf16 v[180:183], a[52:55], v[60:63], v[180:183]
    ds_read_b64_tr_b16 a[74:75], v46 offset:45056
    ds_read_b64_tr_b16 a[76:77], v47 offset:40960
    s_waitcnt lgkmcnt(7)
    v_mfma_f32_16x16x32_bf16 v[184:187], a[56:59], v[60:63], v[184:187]
    v_exp_f32 v110, v110
    s_waitcnt lgkmcnt(5)
    v_mfma_f32_16x16x32_bf16 v[188:191], a[60:63], v[60:63], v[188:191]
    ds_read_b64_tr_b16 a[78:79], v47 offset:45056
    v_cvt_pk_bf16_f32 v66, v108, v109
    s_waitcnt lgkmcnt(4)
    v_mfma_f32_16x16x32_bf16 v[192:195], a[64:67], v[60:63], v[192:195]
    v_exp_f32 v111, v111
    s_waitcnt lgkmcnt(3)
    v_mfma_f32_16x16x32_bf16 v[196:199], a[68:71], v[60:63], v[196:199]
    s_nop 0
    v_cvt_pk_bf16_f32 v67, v110, v111
    s_waitcnt lgkmcnt(2)
    v_mfma_f32_16x16x32_bf16 v[200:203], a[72:75], v[60:63], v[200:203]
    v_accvgpr_read_b32 v48, a96
    s_mov_b32 s31, 0x53800000
    v_rcp_f32 v50, v48
    s_waitcnt lgkmcnt(0)
    v_mfma_f32_16x16x32_bf16 v[204:207], a[76:79], v[60:63], v[204:207]
    v_mul_f32 v176, v50, v176
    v_mul_f32 v177, v50, v177
    v_mfma_f32_16x16x32_bf16 a[100:103], a[108:111], v[64:67], a[100:103]
    v_mul_f32 v178, v50, v178
    v_mul_f32 v179, v50, v179
    v_mfma_f32_16x16x32_bf16 v[208:211], a[48:51], v[64:67], v[208:211]
    v_cvt_pk_bf16_f32 v176, v176, v177
    v_cvt_pk_bf16_f32 v177, v178, v179
    v_mfma_f32_16x16x32_bf16 v[212:215], a[52:55], v[64:67], v[212:215]
    ds_write_b64 v18, v[176:177]
    v_mul_f32 v180, v50, v180
    v_mfma_f32_16x16x32_bf16 v[216:219], a[56:59], v[64:67], v[216:219]
    v_mul_f32 v181, v50, v181
    v_mul_f32 v182, v50, v182
    v_mfma_f32_16x16x32_bf16 v[220:223], a[60:63], v[64:67], v[220:223]
    v_mul_f32 v183, v50, v183
    v_cvt_pk_bf16_f32 v180, v180, v181
    v_mfma_f32_16x16x32_bf16 v[224:227], a[64:67], v[64:67], v[224:227]
    v_cvt_pk_bf16_f32 v181, v182, v183
    ds_write_b64 v18, v[180:181] offset:32
    v_mfma_f32_16x16x32_bf16 v[228:231], a[68:71], v[64:67], v[228:231]
    v_mfma_f32_16x16x32_bf16 v[232:235], a[72:75], v[64:67], v[232:235]
    v_mfma_f32_16x16x32_bf16 v[236:239], a[76:79], v[64:67], v[236:239]
    v_accvgpr_read_b32 v49, a100
    v_sub_f32 v52, 0, v128
    v_accvgpr_read_b32 v53, a104
    ds_write_b128 v8, a[80:83]
    ds_write_b128 v8, a[84:87] offset:1024
    ds_write_b128 v8, a[88:91] offset:2048
    ds_write_b128 v8, a[92:95] offset:3072
    ds_write_b64 v10, v[52:53]
    v_rcp_f32 v51, v49
    s_nop 0
    v_pk_mul_f32 v[184:185], v[184:185], v[50:51] op_sel:[0,0] op_sel_hi:[1,0]
    v_pk_mul_f32 v[186:187], v[186:187], v[50:51] op_sel:[0,0] op_sel_hi:[1,0]
    v_cvt_pk_bf16_f32 v184, v184, v185
    v_cvt_pk_bf16_f32 v185, v186, v187
    ds_write_b64 v18, v[184:185] offset:64
    v_pk_mul_f32 v[188:189], v[188:189], v[50:51] op_sel:[0,0] op_sel_hi:[1,0]
    v_pk_mul_f32 v[190:191], v[190:191], v[50:51] op_sel:[0,0] op_sel_hi:[1,0]
    v_cvt_pk_bf16_f32 v188, v188, v189
    v_cvt_pk_bf16_f32 v189, v190, v191
    ds_write_b64 v18, v[188:189] offset:96
    v_pk_mul_f32 v[192:193], v[192:193], v[50:51] op_sel:[0,0] op_sel_hi:[1,0]
    v_pk_mul_f32 v[194:195], v[194:195], v[50:51] op_sel:[0,0] op_sel_hi:[1,0]
    v_cvt_pk_bf16_f32 v192, v192, v193
    v_cvt_pk_bf16_f32 v193, v194, v195
    ds_write_b64 v18, v[192:193] offset:128
    v_pk_mul_f32 v[196:197], v[196:197], v[50:51] op_sel:[0,0] op_sel_hi:[1,0]
    v_pk_mul_f32 v[198:199], v[198:199], v[50:51] op_sel:[0,0] op_sel_hi:[1,0]
    v_cvt_pk_bf16_f32 v196, v196, v197
    v_cvt_pk_bf16_f32 v197, v198, v199
    ds_write_b64 v18, v[196:197] offset:160
    v_pk_mul_f32 v[200:201], v[200:201], v[50:51] op_sel:[0,0] op_sel_hi:[1,0]
    v_pk_mul_f32 v[202:203], v[202:203], v[50:51] op_sel:[0,0] op_sel_hi:[1,0]
    v_cvt_pk_bf16_f32 v200, v200, v201
    v_cvt_pk_bf16_f32 v201, v202, v203
    ds_write_b64 v18, v[200:201] offset:192
    v_pk_mul_f32 v[204:205], v[204:205], v[50:51] op_sel:[0,0] op_sel_hi:[1,0]
    v_pk_mul_f32 v[206:207], v[206:207], v[50:51] op_sel:[0,0] op_sel_hi:[1,0]
    v_cvt_pk_bf16_f32 v204, v204, v205
    v_cvt_pk_bf16_f32 v205, v206, v207
    ds_write_b64 v18, v[204:205] offset:224
    v_pk_mul_f32 v[208:209], v[208:209], v[50:51] op_sel:[0,1] op_sel_hi:[1,1]
    v_pk_mul_f32 v[210:211], v[210:211], v[50:51] op_sel:[0,1] op_sel_hi:[1,1]
    v_cvt_pk_bf16_f32 v208, v208, v209
    v_cvt_pk_bf16_f32 v209, v210, v211
    ds_write_b64 v18, v[208:209] offset:4352
    s_waitcnt lgkmcnt(1)
    ds_read_b128 v[96:99], v20
    ds_read_b128 v[100:103], v20 offset:1088
    ds_read_b128 v[104:107], v20 offset:2176
    ds_read_b128 v[108:111], v20 offset:3264
    s_barrier
    ds_read_b128 v[72:75], v9
    ds_read_b128 v[76:79], v9 offset:1024
    ds_read_b128 v[80:83], v9 offset:2048
    ds_read_b128 v[84:87], v9 offset:3072
    ds_read_b64 v[54:55], v11
    v_pk_mul_f32 v[212:213], v[212:213], v[50:51] op_sel:[0,1] op_sel_hi:[1,1]
    v_pk_mul_f32 v[214:215], v[214:215], v[50:51] op_sel:[0,1] op_sel_hi:[1,1]
    v_cvt_pk_bf16_f32 v212, v212, v213
    v_cvt_pk_bf16_f32 v213, v214, v215
    ds_write_b64 v18, v[212:213] offset:4384
    s_waitcnt lgkmcnt(9)
    buffer_store_dwordx4 v[96:99], v19, s[20:23], s24 offen nt
    s_waitcnt lgkmcnt(1)
    v_max_f32 v1, v52, v54
    v_sub_f32 v2, v52, v1
    v_sub_f32 v3, v54, v1
    v_pk_mul_f32 v[216:217], v[216:217], v[50:51] op_sel:[0,1] op_sel_hi:[1,1]
    v_pk_mul_f32 v[218:219], v[218:219], v[50:51] op_sel:[0,1] op_sel_hi:[1,1]
    v_cvt_pk_bf16_f32 v216, v216, v217
    v_cvt_pk_bf16_f32 v217, v218, v219
    ds_write_b64 v18, v[216:217] offset:4416
    buffer_store_dwordx4 v[100:103], v19, s[20:23], s24 offen offset:1024 nt
    v_exp_f32 v2, v2
    v_exp_f32 v3, v3
    v_cmp_nle_f32 s[54:55], v53, s31
    v_pk_mul_f32 v[220:221], v[220:221], v[50:51] op_sel:[0,1] op_sel_hi:[1,1]
    v_pk_mul_f32 v[222:223], v[222:223], v[50:51] op_sel:[0,1] op_sel_hi:[1,1]
    v_cvt_pk_bf16_f32 v220, v220, v221
    v_cvt_pk_bf16_f32 v221, v222, v223
    ds_write_b64 v18, v[220:221] offset:4448
    buffer_store_dwordx4 v[104:107], v19, s[20:23], s24 offen offset:2048 nt
    v_cmp_nle_f32 s[56:57], v55, s31
    v_mul_f32 v1, v2, v53
    v_fmac_f32 v1, v3, v55
    v_pk_mul_f32 v[224:225], v[224:225], v[50:51] op_sel:[0,1] op_sel_hi:[1,1]
    v_pk_mul_f32 v[226:227], v[226:227], v[50:51] op_sel:[0,1] op_sel_hi:[1,1]
    v_cvt_pk_bf16_f32 v224, v224, v225
    v_cvt_pk_bf16_f32 v225, v226, v227
    ds_write_b64 v18, v[224:225] offset:4480
    buffer_store_dwordx4 v[108:111], v19, s[20:23], s24 offen offset:3072 nt
    s_or_b64 s[54:55], s[54:55], s[56:57]
    v_rcp_f32 v1, v1
    v_cmp_nle_f32 s[52:53], v48, s31
    v_pk_mul_f32 v[228:229], v[228:229], v[50:51] op_sel:[0,1] op_sel_hi:[1,1]
    v_pk_mul_f32 v[230:231], v[230:231], v[50:51] op_sel:[0,1] op_sel_hi:[1,1]
    v_cvt_pk_bf16_f32 v228, v228, v229
    v_cvt_pk_bf16_f32 v229, v230, v231
    ds_write_b64 v18, v[228:229] offset:4512
    v_cmp_nle_f32 s[56:57], v49, s31
    v_mul_f32 v56, v2, v1
    v_mul_f32 v57, v3, v1
    v_pk_mul_f32 v[232:233], v[232:233], v[50:51] op_sel:[0,1] op_sel_hi:[1,1]
    v_pk_mul_f32 v[234:235], v[234:235], v[50:51] op_sel:[0,1] op_sel_hi:[1,1]
    v_cvt_pk_bf16_f32 v232, v232, v233
    v_cvt_pk_bf16_f32 v233, v234, v235
    ds_write_b64 v18, v[232:233] offset:4544
    s_or_b64 s[52:53], s[52:53], s[56:57]
    v_pk_mul_f32 v[236:237], v[236:237], v[50:51] op_sel:[0,1] op_sel_hi:[1,1]
    v_pk_mul_f32 v[238:239], v[238:239], v[50:51] op_sel:[0,1] op_sel_hi:[1,1]
    v_cvt_pk_bf16_f32 v236, v236, v237
    v_cvt_pk_bf16_f32 v237, v238, v239
    ds_write_b64 v18, v[236:237] offset:4576
    s_mov_b32 s4, s20
    s_mov_b32 s5, s21
    s_mov_b32 s7, 0x20000
    s_cmp_lg_u64 s[54:55], 0
    s_cselect_b32 s6, 0, 40960
    s_add_u32 s30, s24, 4096
    s_lshl_b32 s32, s35, 7
    s_add_u32 s32, s32, s90
    s_add_u32 s33, s32, 2048
    v_pk_mul_f32 v[240:241], v[240:241], v[56:57] op_sel:[0,0] op_sel_hi:[1,0]
    v_pk_mul_f32 v[242:243], v[242:243], v[56:57] op_sel:[0,0] op_sel_hi:[1,0]
    v_pk_fma_f32 v[240:241], v[72:73], v[56:57], v[240:241] op_sel:[0,1,0] op_sel_hi:[1,1,1]
    v_pk_fma_f32 v[242:243], v[74:75], v[56:57], v[242:243] op_sel:[0,1,0] op_sel_hi:[1,1,1]
    v_cvt_pk_bf16_f32 v240, v240, v241
    v_cvt_pk_bf16_f32 v241, v242, v243
    ds_write_b64 v21, v[240:241]
    v_pk_mul_f32 v[244:245], v[244:245], v[56:57] op_sel:[0,0] op_sel_hi:[1,0]
    v_pk_mul_f32 v[246:247], v[246:247], v[56:57] op_sel:[0,0] op_sel_hi:[1,0]
    v_pk_fma_f32 v[244:245], v[76:77], v[56:57], v[244:245] op_sel:[0,1,0] op_sel_hi:[1,1,1]
    v_pk_fma_f32 v[246:247], v[78:79], v[56:57], v[246:247] op_sel:[0,1,0] op_sel_hi:[1,1,1]
    v_cvt_pk_bf16_f32 v244, v244, v245
    v_cvt_pk_bf16_f32 v245, v246, v247
    ds_write_b64 v21, v[244:245] offset:32
    s_waitcnt lgkmcnt(2)
    ds_read_b128 v[176:179], v20 offset:4352
    ds_read_b128 v[180:183], v20 offset:5440
    ds_read_b128 v[184:187], v20 offset:6528
    ds_read_b128 v[188:191], v20 offset:7616
    v_pk_mul_f32 v[248:249], v[248:249], v[56:57] op_sel:[0,0] op_sel_hi:[1,0]
    v_pk_mul_f32 v[250:251], v[250:251], v[56:57] op_sel:[0,0] op_sel_hi:[1,0]
    v_pk_fma_f32 v[248:249], v[80:81], v[56:57], v[248:249] op_sel:[0,1,0] op_sel_hi:[1,1,1]
    v_pk_fma_f32 v[250:251], v[82:83], v[56:57], v[250:251] op_sel:[0,1,0] op_sel_hi:[1,1,1]
    v_cvt_pk_bf16_f32 v248, v248, v249
    v_cvt_pk_bf16_f32 v249, v250, v251
    ds_write_b64 v21, v[248:249] offset:64
    v_pk_mul_f32 v[252:253], v[252:253], v[56:57] op_sel:[0,0] op_sel_hi:[1,0]
    v_pk_mul_f32 v[254:255], v[254:255], v[56:57] op_sel:[0,0] op_sel_hi:[1,0]
    v_pk_fma_f32 v[252:253], v[84:85], v[56:57], v[252:253] op_sel:[0,1,0] op_sel_hi:[1,1,1]
    v_pk_fma_f32 v[254:255], v[86:87], v[56:57], v[254:255] op_sel:[0,1,0] op_sel_hi:[1,1,1]
    v_cvt_pk_bf16_f32 v252, v252, v253
    v_cvt_pk_bf16_f32 v253, v254, v255
    ds_write_b64 v21, v[252:253] offset:96
    s_waitcnt lgkmcnt(5)
    buffer_store_dwordx4 v[176:179], v19, s[20:23], s30 offen nt
    s_waitcnt lgkmcnt(4)
    buffer_store_dwordx4 v[180:183], v19, s[20:23], s30 offen offset:1024 nt
    s_waitcnt lgkmcnt(3)
    buffer_store_dwordx4 v[184:187], v19, s[20:23], s30 offen offset:2048 nt
    s_waitcnt lgkmcnt(2)
    buffer_store_dwordx4 v[188:191], v19, s[20:23], s30 offen offset:3072 nt
    s_waitcnt lgkmcnt(0)
    ds_read_b128 v[240:243], v22
    ds_read_b128 v[244:247], v22 offset:1152
    s_waitcnt lgkmcnt(1)
    buffer_store_dwordx4 v[240:243], v23, s[4:7], s32 offen nt
    s_waitcnt lgkmcnt(0)
    buffer_store_dwordx4 v[244:247], v23, s[4:7], s33 offen nt
    s_or_b64 s[56:57], s[52:53], s[54:55]
    s_cbranch_scc1 L_slow
L_end:
    s_endpgm
L_slow:
    s_waitcnt vmcnt(0) lgkmcnt(0)
    s_mov_b32 s22, 40960
    v_bfe_u32 v1, v19, 4, 5
    v_lshrrev_b32 v2, 9, v19
    v_lshlrev_b32 v4, 4, v2
    v_lshl_add_u32 v4, v1, 8, v4
    s_cmp_lg_u64 s[52:53], 0
    s_cbranch_scc0 L_slow_sh
    s_mov_b32 s33, s24
    s_mov_b64 s[52:53], 0
    s_mov_b64 s[56:57], -1
    s_branch L_slow_tile
L_slow_sh:
    s_cmp_lg_u64 s[54:55], 0
    s_cbranch_scc0 L_end
    s_cmp_lg_u32 s35, 0
    s_cbranch_scc1 L_end
    s_mov_b32 s33, 32768
    s_mov_b64 s[54:55], 0
    s_lshl_b32 s38, s3, 4
    s_lshl_b32 s56, 0xffff, s38
    s_mov_b32 s57, s56
L_slow_tile:
    buffer_load_dwordx4 v[144:147], v4, s[8:11], s33 offen
    buffer_load_dwordx4 v[148:151], v4, s[8:11], s33 offen offset:32
    buffer_load_dwordx4 v[152:155], v4, s[8:11], s33 offen offset:64
    buffer_load_dwordx4 v[156:159], v4, s[8:11], s33 offen offset:96
    buffer_load_dwordx4 v[160:163], v4, s[8:11], s33 offen offset:128
    buffer_load_dwordx4 v[164:167], v4, s[8:11], s33 offen offset:160
    buffer_load_dwordx4 v[168:171], v4, s[8:11], s33 offen offset:192
    buffer_load_dwordx4 v[172:175], v4, s[8:11], s33 offen offset:224
    s_waitcnt vmcnt(0)
    v_lshlrev_b32 v240, 16, v144
    v_lshlrev_b32 v242, 16, v145
    v_lshlrev_b32 v244, 16, v146
    v_lshlrev_b32 v246, 16, v147
    v_and_b32 v241, s28, v144
    v_and_b32 v243, s28, v145
    v_and_b32 v245, s28, v146
    v_and_b32 v247, s28, v147
    v_mul_f32 v240, s27, v240
    v_mul_f32 v242, s27, v242
    v_mul_f32 v244, s27, v244
    v_mul_f32 v246, s27, v246
    v_mul_f32 v241, s27, v241
    v_mul_f32 v243, s27, v243
    v_mul_f32 v245, s27, v245
    v_mul_f32 v247, s27, v247
    v_cvt_pk_bf16_f32 v144, v240, v241
    v_cvt_pk_bf16_f32 v145, v242, v243
    v_cvt_pk_bf16_f32 v146, v244, v245
    v_cvt_pk_bf16_f32 v147, v246, v247
    v_lshlrev_b32 v240, 16, v148
    v_lshlrev_b32 v242, 16, v149
    v_lshlrev_b32 v244, 16, v150
    v_lshlrev_b32 v246, 16, v151
    v_and_b32 v241, s28, v148
    v_and_b32 v243, s28, v149
    v_and_b32 v245, s28, v150
    v_and_b32 v247, s28, v151
    v_mul_f32 v240, s27, v240
    v_mul_f32 v242, s27, v242
    v_mul_f32 v244, s27, v244
    v_mul_f32 v246, s27, v246
    v_mul_f32 v241, s27, v241
    v_mul_f32 v243, s27, v243
    v_mul_f32 v245, s27, v245
    v_mul_f32 v247, s27, v247
    v_cvt_pk_bf16_f32 v148, v240, v241
    v_cvt_pk_bf16_f32 v149, v242, v243
    v_cvt_pk_bf16_f32 v150, v244, v245
    v_cvt_pk_bf16_f32 v151, v246, v247
    v_lshlrev_b32 v240, 16, v152
    v_lshlrev_b32 v242, 16, v153
    v_lshlrev_b32 v244, 16, v154
    v_lshlrev_b32 v246, 16, v155
    v_and_b32 v241, s28, v152
    v_and_b32 v243, s28, v153
    v_and_b32 v245, s28, v154
    v_and_b32 v247, s28, v155
    v_mul_f32 v240, s27, v240
    v_mul_f32 v242, s27, v242
    v_mul_f32 v244, s27, v244
    v_mul_f32 v246, s27, v246
    v_mul_f32 v241, s27, v241
    v_mul_f32 v243, s27, v243
    v_mul_f32 v245, s27, v245
    v_mul_f32 v247, s27, v247
    v_cvt_pk_bf16_f32 v152, v240, v241
    v_cvt_pk_bf16_f32 v153, v242, v243
    v_cvt_pk_bf16_f32 v154, v244, v245
    v_cvt_pk_bf16_f32 v155, v246, v247
    v_lshlrev_b32 v240, 16, v156
    v_lshlrev_b32 v242, 16, v157
    v_lshlrev_b32 v244, 16, v158
    v_lshlrev_b32 v246, 16, v159
    v_and_b32 v241, s28, v156
    v_and_b32 v243, s28, v157
    v_and_b32 v245, s28, v158
    v_and_b32 v247, s28, v159
    v_mul_f32 v240, s27, v240
    v_mul_f32 v242, s27, v242
    v_mul_f32 v244, s27, v244
    v_mul_f32 v246, s27, v246
    v_mul_f32 v241, s27, v241
    v_mul_f32 v243, s27, v243
    v_mul_f32 v245, s27, v245
    v_mul_f32 v247, s27, v247
    v_cvt_pk_bf16_f32 v156, v240, v241
    v_cvt_pk_bf16_f32 v157, v242, v243
    v_cvt_pk_bf16_f32 v158, v244, v245
    v_cvt_pk_bf16_f32 v159, v246, v247
    v_lshlrev_b32 v240, 16, v160
    v_lshlrev_b32 v242, 16, v161
    v_lshlrev_b32 v244, 16, v162
    v_lshlrev_b32 v246, 16, v163
    v_and_b32 v241, s28, v160
    v_and_b32 v243, s28, v161
    v_and_b32 v245, s28, v162
    v_and_b32 v247, s28, v163
    v_mul_f32 v240, s27, v240
    v_mul_f32 v242, s27, v242
    v_mul_f32 v244, s27, v244
    v_mul_f32 v246, s27, v246
    v_mul_f32 v241, s27, v241
    v_mul_f32 v243, s27, v243
    v_mul_f32 v245, s27, v245
    v_mul_f32 v247, s27, v247
    v_cvt_pk_bf16_f32 v160, v240, v241
    v_cvt_pk_bf16_f32 v161, v242, v243
    v_cvt_pk_bf16_f32 v162, v244, v245
    v_cvt_pk_bf16_f32 v163, v246, v247
    v_lshlrev_b32 v240, 16, v164
    v_lshlrev_b32 v242, 16, v165
    v_lshlrev_b32 v244, 16, v166
    v_lshlrev_b32 v246, 16, v167
    v_and_b32 v241, s28, v164
    v_and_b32 v243, s28, v165
    v_and_b32 v245, s28, v166
    v_and_b32 v247, s28, v167
    v_mul_f32 v240, s27, v240
    v_mul_f32 v242, s27, v242
    v_mul_f32 v244, s27, v244
    v_mul_f32 v246, s27, v246
    v_mul_f32 v241, s27, v241
    v_mul_f32 v243, s27, v243
    v_mul_f32 v245, s27, v245
    v_mul_f32 v247, s27, v247
    v_cvt_pk_bf16_f32 v164, v240, v241
    v_cvt_pk_bf16_f32 v165, v242, v243
    v_cvt_pk_bf16_f32 v166, v244, v245
    v_cvt_pk_bf16_f32 v167, v246, v247
    v_lshlrev_b32 v240, 16, v168
    v_lshlrev_b32 v242, 16, v169
    v_lshlrev_b32 v244, 16, v170
    v_lshlrev_b32 v246, 16, v171
    v_and_b32 v241, s28, v168
    v_and_b32 v243, s28, v169
    v_and_b32 v245, s28, v170
    v_and_b32 v247, s28, v171
    v_mul_f32 v240, s27, v240
    v_mul_f32 v242, s27, v242
    v_mul_f32 v244, s27, v244
    v_mul_f32 v246, s27, v246
    v_mul_f32 v241, s27, v241
    v_mul_f32 v243, s27, v243
    v_mul_f32 v245, s27, v245
    v_mul_f32 v247, s27, v247
    v_cvt_pk_bf16_f32 v168, v240, v241
    v_cvt_pk_bf16_f32 v169, v242, v243
    v_cvt_pk_bf16_f32 v170, v244, v245
    v_cvt_pk_bf16_f32 v171, v246, v247
    v_lshlrev_b32 v240, 16, v172
    v_lshlrev_b32 v242, 16, v173
    v_lshlrev_b32 v244, 16, v174
    v_lshlrev_b32 v246, 16, v175
    v_and_b32 v241, s28, v172
    v_and_b32 v243, s28, v173
    v_and_b32 v245, s28, v174
    v_and_b32 v247, s28, v175
    v_mul_f32 v240, s27, v240
    v_mul_f32 v242, s27, v242
    v_mul_f32 v244, s27, v244
    v_mul_f32 v246, s27, v246
    v_mul_f32 v241, s27, v241
    v_mul_f32 v243, s27, v243
    v_mul_f32 v245, s27, v245
    v_mul_f32 v247, s27, v247
    v_cvt_pk_bf16_f32 v172, v240, v241
    v_cvt_pk_bf16_f32 v173, v242, v243
    v_cvt_pk_bf16_f32 v174, v244, v245
    v_cvt_pk_bf16_f32 v175, v246, v247
    v_mov_b32 v6, 0xff800000
    s_mov_b32 s38, 0
L_slow_p1:
    buffer_load_dwordx4 v[80:83], v4, s[12:15], s38 offen
    buffer_load_dwordx4 v[84:87], v4, s[12:15], s38 offen offset:32
    buffer_load_dwordx4 v[88:91], v4, s[12:15], s38 offen offset:64
    buffer_load_dwordx4 v[92:95], v4, s[12:15], s38 offen offset:96
    buffer_load_dwordx4 v[96:99], v4, s[12:15], s38 offen offset:128
    buffer_load_dwordx4 v[100:103], v4, s[12:15], s38 offen offset:160
    buffer_load_dwordx4 v[104:107], v4, s[12:15], s38 offen offset:192
    buffer_load_dwordx4 v[108:111], v4, s[12:15], s38 offen offset:224
    s_waitcnt vmcnt(0)
    v_mfma_f32_32x32x16_bf16 v[112:127], v[80:83], v[144:147], 0
    v_mfma_f32_32x32x16_bf16 v[112:127], v[84:87], v[148:151], v[112:127]
    v_mfma_f32_32x32x16_bf16 v[112:127], v[88:91], v[152:155], v[112:127]
    v_mfma_f32_32x32x16_bf16 v[112:127], v[92:95], v[156:159], v[112:127]
    v_mfma_f32_32x32x16_bf16 v[112:127], v[96:99], v[160:163], v[112:127]
    v_mfma_f32_32x32x16_bf16 v[112:127], v[100:103], v[164:167], v[112:127]
    v_mfma_f32_32x32x16_bf16 v[112:127], v[104:107], v[168:171], v[112:127]
    v_mfma_f32_32x32x16_bf16 v[112:127], v[108:111], v[172:175], v[112:127]
    s_nop 15
    v_max_f32 v6, v6, v112
    v_max_f32 v6, v6, v113
    v_max_f32 v6, v6, v114
    v_max_f32 v6, v6, v115
    v_max_f32 v6, v6, v116
    v_max_f32 v6, v6, v117
    v_max_f32 v6, v6, v118
    v_max_f32 v6, v6, v119
    v_max_f32 v6, v6, v120
    v_max_f32 v6, v6, v121
    v_max_f32 v6, v6, v122
    v_max_f32 v6, v6, v123
    v_max_f32 v6, v6, v124
    v_max_f32 v6, v6, v125
    v_max_f32 v6, v6, v126
    v_max_f32 v6, v6, v127
    s_add_u32 s38, s38, 8192
    s_cmp_lt_u32 s38, 262144
    s_cbranch_scc1 L_slow_p1
    v_mov_b32 v1, v6
    s_nop 1
    v_permlane32_swap_b32 v6, v1
    v_max_f32 v6, v6, v1
    v_mov_b32 v7, 0
    v_mov_b32 v176, 0
    v_mov_b32 v177, 0
    v_mov_b32 v178, 0
    v_mov_b32 v179, 0
    v_mov_b32 v180, 0
    v_mov_b32 v181, 0
    v_mov_b32 v182, 0
    v_mov_b32 v183, 0
    v_mov_b32 v184, 0
    v_mov_b32 v185, 0
    v_mov_b32 v186, 0
    v_mov_b32 v187, 0
    v_mov_b32 v188, 0
    v_mov_b32 v189, 0
    v_mov_b32 v190, 0
    v_mov_b32 v191, 0
    v_mov_b32 v192, 0
    v_mov_b32 v193, 0
    v_mov_b32 v194, 0
    v_mov_b32 v195, 0
    v_mov_b32 v196, 0
    v_mov_b32 v197, 0
    v_mov_b32 v198, 0
    v_mov_b32 v199, 0
    v_mov_b32 v200, 0
    v_mov_b32 v201, 0
    v_mov_b32 v202, 0
    v_mov_b32 v203, 0
    v_mov_b32 v204, 0
    v_mov_b32 v205, 0
    v_mov_b32 v206, 0
    v_mov_b32 v207, 0
    v_mov_b32 v208, 0
    v_mov_b32 v209, 0
    v_mov_b32 v210, 0
    v_mov_b32 v211, 0
    v_mov_b32 v212, 0
    v_mov_b32 v213, 0
    v_mov_b32 v214, 0
    v_mov_b32 v215, 0
    v_mov_b32 v216, 0
    v_mov_b32 v217, 0
    v_mov_b32 v218, 0
    v_mov_b32 v219, 0
    v_mov_b32 v220, 0
    v_mov_b32 v221, 0
    v_mov_b32 v222, 0
    v_mov_b32 v223, 0
    v_mov_b32 v224, 0
    v_mov_b32 v225, 0
    v_mov_b32 v226, 0
    v_mov_b32 v227, 0
    v_mov_b32 v228, 0
    v_mov_b32 v229, 0
    v_mov_b32 v230, 0
    v_mov_b32 v231, 0
    v_mov_b32 v232, 0
    v_mov_b32 v233, 0
    v_mov_b32 v234, 0
    v_mov_b32 v235, 0
    v_mov_b32 v236, 0
    v_mov_b32 v237, 0
    v_mov_b32 v238, 0
    v_mov_b32 v239, 0
    v_lshrrev_b32 v2, 8, v4
    v_bfe_u32 v3, v4, 4, 1
    v_lshlrev_b32 v2, 1, v2
    v_lshl_add_u32 v2, v3, 10, v2
    s_mov_b32 s38, 0
L_slow_p2:
    buffer_load_dwordx4 v[80:83], v4, s[12:15], s38 offen
    buffer_load_dwordx4 v[84:87], v4, s[12:15], s38 offen offset:32
    buffer_load_dwordx4 v[88:91], v4, s[12:15], s38 offen offset:64
    buffer_load_dwordx4 v[92:95], v4, s[12:15], s38 offen offset:96
    buffer_load_dwordx4 v[96:99], v4, s[12:15], s38 offen offset:128
    buffer_load_dwordx4 v[100:103], v4, s[12:15], s38 offen offset:160
    buffer_load_dwordx4 v[104:107], v4, s[12:15], s38 offen offset:192
    buffer_load_dwordx4 v[108:111], v4, s[12:15], s38 offen offset:224
    s_waitcnt vmcnt(0)
    v_mfma_f32_32x32x16_bf16 v[112:127], v[80:83], v[144:147], 0
    v_mfma_f32_32x32x16_bf16 v[112:127], v[84:87], v[148:151], v[112:127]
    v_mfma_f32_32x32x16_bf16 v[112:127], v[88:91], v[152:155], v[112:127]
    v_mfma_f32_32x32x16_bf16 v[112:127], v[92:95], v[156:159], v[112:127]
    v_mfma_f32_32x32x16_bf16 v[112:127], v[96:99], v[160:163], v[112:127]
    v_mfma_f32_32x32x16_bf16 v[112:127], v[100:103], v[164:167], v[112:127]
    v_mfma_f32_32x32x16_bf16 v[112:127], v[104:107], v[168:171], v[112:127]
    v_mfma_f32_32x32x16_bf16 v[112:127], v[108:111], v[172:175], v[112:127]
    s_nop 15
    v_sub_f32 v112, v112, v6
    v_sub_f32 v113, v113, v6
    v_sub_f32 v114, v114, v6
    v_sub_f32 v115, v115, v6
    v_sub_f32 v116, v116, v6
    v_sub_f32 v117, v117, v6
    v_sub_f32 v118, v118, v6
    v_sub_f32 v119, v119, v6
    v_sub_f32 v120, v120, v6
    v_sub_f32 v121, v121, v6
    v_sub_f32 v122, v122, v6
    v_sub_f32 v123, v123, v6
    v_sub_f32 v124, v124, v6
    v_sub_f32 v125, v125, v6
    v_sub_f32 v126, v126, v6
    v_sub_f32 v127, v127, v6
    v_exp_f32 v112, v112
    v_exp_f32 v113, v113
    v_exp_f32 v114, v114
    v_exp_f32 v115, v115
    v_exp_f32 v116, v116
    v_exp_f32 v117, v117
    v_exp_f32 v118, v118
    v_exp_f32 v119, v119
    v_exp_f32 v120, v120
    v_exp_f32 v121, v121
    v_exp_f32 v122, v122
    v_exp_f32 v123, v123
    v_exp_f32 v124, v124
    v_exp_f32 v125, v125
    v_exp_f32 v126, v126
    v_exp_f32 v127, v127
    s_nop 0
    v_add_f32 v7, v7, v112
    v_add_f32 v7, v7, v113
    v_add_f32 v7, v7, v114
    v_add_f32 v7, v7, v115
    v_add_f32 v7, v7, v116
    v_add_f32 v7, v7, v117
    v_add_f32 v7, v7, v118
    v_add_f32 v7, v7, v119
    v_add_f32 v7, v7, v120
    v_add_f32 v7, v7, v121
    v_add_f32 v7, v7, v122
    v_add_f32 v7, v7, v123
    v_add_f32 v7, v7, v124
    v_add_f32 v7, v7, v125
    v_add_f32 v7, v7, v126
    v_add_f32 v7, v7, v127
    v_cvt_pk_bf16_f32 v72, v112, v113
    v_cvt_pk_bf16_f32 v73, v114, v115
    v_cvt_pk_bf16_f32 v74, v116, v117
    v_cvt_pk_bf16_f32 v75, v118, v119
    v_cvt_pk_bf16_f32 v76, v120, v121
    v_cvt_pk_bf16_f32 v77, v122, v123
    v_cvt_pk_bf16_f32 v78, v124, v125
    v_cvt_pk_bf16_f32 v79, v126, v127
    s_add_u32 s39, s38, 0
    buffer_load_ushort v80, v2, s[16:19], s39 offen
    buffer_load_ushort v81, v2, s[16:19], s39 offen offset:256
    buffer_load_ushort v82, v2, s[16:19], s39 offen offset:512
    buffer_load_ushort v83, v2, s[16:19], s39 offen offset:768
    buffer_load_ushort v84, v2, s[16:19], s39 offen offset:2048
    buffer_load_ushort v85, v2, s[16:19], s39 offen offset:2304
    buffer_load_ushort v86, v2, s[16:19], s39 offen offset:2560
    buffer_load_ushort v87, v2, s[16:19], s39 offen offset:2816
    buffer_load_ushort v88, v2, s[16:19], s39 offen offset:64
    buffer_load_ushort v89, v2, s[16:19], s39 offen offset:320
    buffer_load_ushort v90, v2, s[16:19], s39 offen offset:576
    buffer_load_ushort v91, v2, s[16:19], s39 offen offset:832
    buffer_load_ushort v92, v2, s[16:19], s39 offen offset:2112
    buffer_load_ushort v93, v2, s[16:19], s39 offen offset:2368
    buffer_load_ushort v94, v2, s[16:19], s39 offen offset:2624
    buffer_load_ushort v95, v2, s[16:19], s39 offen offset:2880
    buffer_load_ushort v96, v2, s[16:19], s39 offen offset:128
    buffer_load_ushort v97, v2, s[16:19], s39 offen offset:384
    buffer_load_ushort v98, v2, s[16:19], s39 offen offset:640
    buffer_load_ushort v99, v2, s[16:19], s39 offen offset:896
    buffer_load_ushort v100, v2, s[16:19], s39 offen offset:2176
    buffer_load_ushort v101, v2, s[16:19], s39 offen offset:2432
    buffer_load_ushort v102, v2, s[16:19], s39 offen offset:2688
    buffer_load_ushort v103, v2, s[16:19], s39 offen offset:2944
    buffer_load_ushort v104, v2, s[16:19], s39 offen offset:192
    buffer_load_ushort v105, v2, s[16:19], s39 offen offset:448
    buffer_load_ushort v106, v2, s[16:19], s39 offen offset:704
    buffer_load_ushort v107, v2, s[16:19], s39 offen offset:960
    buffer_load_ushort v108, v2, s[16:19], s39 offen offset:2240
    buffer_load_ushort v109, v2, s[16:19], s39 offen offset:2496
    buffer_load_ushort v110, v2, s[16:19], s39 offen offset:2752
    buffer_load_ushort v111, v2, s[16:19], s39 offen offset:3008
    s_waitcnt vmcnt(0)
    v_lshl_or_b32 v128, v81, 16, v80
    v_lshl_or_b32 v129, v83, 16, v82
    v_lshl_or_b32 v130, v85, 16, v84
    v_lshl_or_b32 v131, v87, 16, v86
    v_lshl_or_b32 v132, v89, 16, v88
    v_lshl_or_b32 v133, v91, 16, v90
    v_lshl_or_b32 v134, v93, 16, v92
    v_lshl_or_b32 v135, v95, 16, v94
    v_lshl_or_b32 v136, v97, 16, v96
    v_lshl_or_b32 v137, v99, 16, v98
    v_lshl_or_b32 v138, v101, 16, v100
    v_lshl_or_b32 v139, v103, 16, v102
    v_lshl_or_b32 v140, v105, 16, v104
    v_lshl_or_b32 v141, v107, 16, v106
    v_lshl_or_b32 v142, v109, 16, v108
    v_lshl_or_b32 v143, v111, 16, v110
    s_nop 1
    v_mfma_f32_32x32x16_bf16 v[176:191], v[128:131], v[72:75], v[176:191]
    v_mfma_f32_32x32x16_bf16 v[192:207], v[132:135], v[72:75], v[192:207]
    v_mfma_f32_32x32x16_bf16 v[208:223], v[136:139], v[72:75], v[208:223]
    v_mfma_f32_32x32x16_bf16 v[224:239], v[140:143], v[72:75], v[224:239]
    s_nop 7
    s_add_u32 s39, s38, 4096
    buffer_load_ushort v80, v2, s[16:19], s39 offen
    buffer_load_ushort v81, v2, s[16:19], s39 offen offset:256
    buffer_load_ushort v82, v2, s[16:19], s39 offen offset:512
    buffer_load_ushort v83, v2, s[16:19], s39 offen offset:768
    buffer_load_ushort v84, v2, s[16:19], s39 offen offset:2048
    buffer_load_ushort v85, v2, s[16:19], s39 offen offset:2304
    buffer_load_ushort v86, v2, s[16:19], s39 offen offset:2560
    buffer_load_ushort v87, v2, s[16:19], s39 offen offset:2816
    buffer_load_ushort v88, v2, s[16:19], s39 offen offset:64
    buffer_load_ushort v89, v2, s[16:19], s39 offen offset:320
    buffer_load_ushort v90, v2, s[16:19], s39 offen offset:576
    buffer_load_ushort v91, v2, s[16:19], s39 offen offset:832
    buffer_load_ushort v92, v2, s[16:19], s39 offen offset:2112
    buffer_load_ushort v93, v2, s[16:19], s39 offen offset:2368
    buffer_load_ushort v94, v2, s[16:19], s39 offen offset:2624
    buffer_load_ushort v95, v2, s[16:19], s39 offen offset:2880
    buffer_load_ushort v96, v2, s[16:19], s39 offen offset:128
    buffer_load_ushort v97, v2, s[16:19], s39 offen offset:384
    buffer_load_ushort v98, v2, s[16:19], s39 offen offset:640
    buffer_load_ushort v99, v2, s[16:19], s39 offen offset:896
    buffer_load_ushort v100, v2, s[16:19], s39 offen offset:2176
    buffer_load_ushort v101, v2, s[16:19], s39 offen offset:2432
    buffer_load_ushort v102, v2, s[16:19], s39 offen offset:2688
    buffer_load_ushort v103, v2, s[16:19], s39 offen offset:2944
    buffer_load_ushort v104, v2, s[16:19], s39 offen offset:192
    buffer_load_ushort v105, v2, s[16:19], s39 offen offset:448
    buffer_load_ushort v106, v2, s[16:19], s39 offen offset:704
    buffer_load_ushort v107, v2, s[16:19], s39 offen offset:960
    buffer_load_ushort v108, v2, s[16:19], s39 offen offset:2240
    buffer_load_ushort v109, v2, s[16:19], s39 offen offset:2496
    buffer_load_ushort v110, v2, s[16:19], s39 offen offset:2752
    buffer_load_ushort v111, v2, s[16:19], s39 offen offset:3008
    s_waitcnt vmcnt(0)
    v_lshl_or_b32 v128, v81, 16, v80
    v_lshl_or_b32 v129, v83, 16, v82
    v_lshl_or_b32 v130, v85, 16, v84
    v_lshl_or_b32 v131, v87, 16, v86
    v_lshl_or_b32 v132, v89, 16, v88
    v_lshl_or_b32 v133, v91, 16, v90
    v_lshl_or_b32 v134, v93, 16, v92
    v_lshl_or_b32 v135, v95, 16, v94
    v_lshl_or_b32 v136, v97, 16, v96
    v_lshl_or_b32 v137, v99, 16, v98
    v_lshl_or_b32 v138, v101, 16, v100
    v_lshl_or_b32 v139, v103, 16, v102
    v_lshl_or_b32 v140, v105, 16, v104
    v_lshl_or_b32 v141, v107, 16, v106
    v_lshl_or_b32 v142, v109, 16, v108
    v_lshl_or_b32 v143, v111, 16, v110
    s_nop 1
    v_mfma_f32_32x32x16_bf16 v[176:191], v[128:131], v[76:79], v[176:191]
    v_mfma_f32_32x32x16_bf16 v[192:207], v[132:135], v[76:79], v[192:207]
    v_mfma_f32_32x32x16_bf16 v[208:223], v[136:139], v[76:79], v[208:223]
    v_mfma_f32_32x32x16_bf16 v[224:239], v[140:143], v[76:79], v[224:239]
    s_nop 7
    s_add_u32 s38, s38, 8192
    s_cmp_lt_u32 s38, 262144
    s_cbranch_scc1 L_slow_p2
    s_nop 15
    v_mov_b32 v1, v7
    s_nop 1
    v_permlane32_swap_b32 v7, v1
    v_add_f32 v7, v7, v1
    v_rcp_f32 v5, v7
    s_nop 0
    v_mul_f32 v176, v5, v176
    v_mul_f32 v177, v5, v177
    v_mul_f32 v178, v5, v178
    v_mul_f32 v179, v5, v179
    v_mul_f32 v180, v5, v180
    v_mul_f32 v181, v5, v181
    v_mul_f32 v182, v5, v182
    v_mul_f32 v183, v5, v183
    v_mul_f32 v184, v5, v184
    v_mul_f32 v185, v5, v185
    v_mul_f32 v186, v5, v186
    v_mul_f32 v187, v5, v187
    v_mul_f32 v188, v5, v188
    v_mul_f32 v189, v5, v189
    v_mul_f32 v190, v5, v190
    v_mul_f32 v191, v5, v191
    v_cvt_pk_bf16_f32 v176, v176, v177
    v_cvt_pk_bf16_f32 v177, v178, v179
    v_cvt_pk_bf16_f32 v178, v180, v181
    v_cvt_pk_bf16_f32 v179, v182, v183
    v_cvt_pk_bf16_f32 v180, v184, v185
    v_cvt_pk_bf16_f32 v181, v186, v187
    v_cvt_pk_bf16_f32 v182, v188, v189
    v_cvt_pk_bf16_f32 v183, v190, v191
    v_permlane32_swap_b32 v176, v178
    v_permlane32_swap_b32 v177, v179
    v_permlane32_swap_b32 v180, v182
    v_permlane32_swap_b32 v181, v183
    s_mov_b64 exec, s[56:57]
    buffer_store_dwordx4 v[176:179], v4, s[20:23], s33 offen
    s_mov_b64 exec, -1
    s_nop 1
    s_mov_b64 exec, s[56:57]
    buffer_store_dwordx4 v[180:183], v4, s[20:23], s33 offen offset:32
    s_mov_b64 exec, -1
    s_nop 1
    v_mul_f32 v192, v5, v192
    v_mul_f32 v193, v5, v193
    v_mul_f32 v194, v5, v194
    v_mul_f32 v195, v5, v195
    v_mul_f32 v196, v5, v196
    v_mul_f32 v197, v5, v197
    v_mul_f32 v198, v5, v198
    v_mul_f32 v199, v5, v199
    v_mul_f32 v200, v5, v200
    v_mul_f32 v201, v5, v201
    v_mul_f32 v202, v5, v202
    v_mul_f32 v203, v5, v203
    v_mul_f32 v204, v5, v204
    v_mul_f32 v205, v5, v205
    v_mul_f32 v206, v5, v206
    v_mul_f32 v207, v5, v207
    v_cvt_pk_bf16_f32 v192, v192, v193
    v_cvt_pk_bf16_f32 v193, v194, v195
    v_cvt_pk_bf16_f32 v194, v196, v197
    v_cvt_pk_bf16_f32 v195, v198, v199
    v_cvt_pk_bf16_f32 v196, v200, v201
    v_cvt_pk_bf16_f32 v197, v202, v203
    v_cvt_pk_bf16_f32 v198, v204, v205
    v_cvt_pk_bf16_f32 v199, v206, v207
    v_permlane32_swap_b32 v192, v194
    v_permlane32_swap_b32 v193, v195
    v_permlane32_swap_b32 v196, v198
    v_permlane32_swap_b32 v197, v199
    s_mov_b64 exec, s[56:57]
    buffer_store_dwordx4 v[192:195], v4, s[20:23], s33 offen offset:64
    s_mov_b64 exec, -1
    s_nop 1
    s_mov_b64 exec, s[56:57]
    buffer_store_dwordx4 v[196:199], v4, s[20:23], s33 offen offset:96
    s_mov_b64 exec, -1
    s_nop 1
    v_mul_f32 v208, v5, v208
    v_mul_f32 v209, v5, v209
    v_mul_f32 v210, v5, v210
    v_mul_f32 v211, v5, v211
    v_mul_f32 v212, v5, v212
    v_mul_f32 v213, v5, v213
    v_mul_f32 v214, v5, v214
    v_mul_f32 v215, v5, v215
    v_mul_f32 v216, v5, v216
    v_mul_f32 v217, v5, v217
    v_mul_f32 v218, v5, v218
    v_mul_f32 v219, v5, v219
    v_mul_f32 v220, v5, v220
    v_mul_f32 v221, v5, v221
    v_mul_f32 v222, v5, v222
    v_mul_f32 v223, v5, v223
    v_cvt_pk_bf16_f32 v208, v208, v209
    v_cvt_pk_bf16_f32 v209, v210, v211
    v_cvt_pk_bf16_f32 v210, v212, v213
    v_cvt_pk_bf16_f32 v211, v214, v215
    v_cvt_pk_bf16_f32 v212, v216, v217
    v_cvt_pk_bf16_f32 v213, v218, v219
    v_cvt_pk_bf16_f32 v214, v220, v221
    v_cvt_pk_bf16_f32 v215, v222, v223
    v_permlane32_swap_b32 v208, v210
    v_permlane32_swap_b32 v209, v211
    v_permlane32_swap_b32 v212, v214
    v_permlane32_swap_b32 v213, v215
    s_mov_b64 exec, s[56:57]
    buffer_store_dwordx4 v[208:211], v4, s[20:23], s33 offen offset:128
    s_mov_b64 exec, -1
    s_nop 1
    s_mov_b64 exec, s[56:57]
    buffer_store_dwordx4 v[212:215], v4, s[20:23], s33 offen offset:160
    s_mov_b64 exec, -1
    s_nop 1
    v_mul_f32 v224, v5, v224
    v_mul_f32 v225, v5, v225
    v_mul_f32 v226, v5, v226
    v_mul_f32 v227, v5, v227
    v_mul_f32 v228, v5, v228
    v_mul_f32 v229, v5, v229
    v_mul_f32 v230, v5, v230
    v_mul_f32 v231, v5, v231
    v_mul_f32 v232, v5, v232
    v_mul_f32 v233, v5, v233
    v_mul_f32 v234, v5, v234
    v_mul_f32 v235, v5, v235
    v_mul_f32 v236, v5, v236
    v_mul_f32 v237, v5, v237
    v_mul_f32 v238, v5, v238
    v_mul_f32 v239, v5, v239
    v_cvt_pk_bf16_f32 v224, v224, v225
    v_cvt_pk_bf16_f32 v225, v226, v227
    v_cvt_pk_bf16_f32 v226, v228, v229
    v_cvt_pk_bf16_f32 v227, v230, v231
    v_cvt_pk_bf16_f32 v228, v232, v233
    v_cvt_pk_bf16_f32 v229, v234, v235
    v_cvt_pk_bf16_f32 v230, v236, v237
    v_cvt_pk_bf16_f32 v231, v238, v239
    v_permlane32_swap_b32 v224, v226
    v_permlane32_swap_b32 v225, v227
    v_permlane32_swap_b32 v228, v230
    v_permlane32_swap_b32 v229, v231
    s_mov_b64 exec, s[56:57]
    buffer_store_dwordx4 v[224:227], v4, s[20:23], s33 offen offset:192
    s_mov_b64 exec, -1
    s_nop 1
    s_mov_b64 exec, s[56:57]
    buffer_store_dwordx4 v[228:231], v4, s[20:23], s33 offen offset:224
    s_mov_b64 exec, -1
    s_nop 1
    s_waitcnt vmcnt(0)
    s_branch L_slow_sh
.section .rodata,"a"
.p2align 6
.amdhsa_kernel standalone__gqa_softmax__near_ridge_kernel
  .amdhsa_next_free_vgpr 512
  .amdhsa_next_free_sgpr 96
  .amdhsa_accum_offset 256
  .amdhsa_group_segment_fixed_size 0
  .amdhsa_kernarg_size 48
  .amdhsa_user_sgpr_count 2
  .amdhsa_user_sgpr_kernarg_segment_ptr 1
  .amdhsa_system_sgpr_workgroup_id_x 1
.end_amdhsa_kernel
```
